```python
import torch

def _softmax(x, axis=-1):
    return torch.softmax(x, dim=axis)
def _gelu(x):
    return torch.nn.functional.gelu(x, approximate="tanh")
def _silu(x):
    return torch.nn.functional.silu(x)
def _sigmoid(x):
    return torch.sigmoid(x)
def _layernorm(x, axis=-1, eps=1e-5):
    m = x.mean(dim=axis, keepdim=True)
    v = x.var(dim=axis, keepdim=True, unbiased=False)
    return (x - m) / torch.sqrt(v + eps)
def _scatter_add(tgt, idx, src, axis=0):
    return tgt.clone().index_add_(axis, idx, src)
def _segment_sum(src, seg, n):
    out = torch.zeros((n,) + src.shape[1:], dtype=src.dtype)
    return out.index_add_(0, seg, src)
def _pad(x, pw):
    flat = tuple(v for pair in reversed(pw) for v in pair)
    return torch.nn.functional.pad(x, flat)

kernel_name = 'sequential_preLN__sliding_local_dilated__geglu_ffn__prompt'

def setup_inputs():

    _w = (lambda a: (lambda t: t.to(torch.bfloat16) if t.is_floating_point() else t)(torch.as_tensor(a)))
    def _A_setup():
        B, S, D = 1, 2048, 512
        return {
            "x": _w((lambda *s: torch.randn(*s, dtype=torch.bfloat16) * 0.05)(B, S, D)),
            "wqkv": _w((lambda *s: torch.randn(*s, dtype=torch.bfloat16) * 0.05)(D, 3 * D)),
            "wo": _w((lambda *s: torch.randn(*s, dtype=torch.bfloat16) * 0.05)(D, D)),
        }
    _A_in = _A_setup()

    def _B_setup():
        B, S, D, F = 1, 2048, 512, 1792
        return {
            "x": _w((lambda *s: torch.randn(*s, dtype=torch.bfloat16) * 0.05)(B, S, D)),
            "w_gate": _w((lambda *s: torch.randn(*s, dtype=torch.bfloat16) * 0.05)(D, F)),
            "w_up": _w((lambda *s: torch.randn(*s, dtype=torch.bfloat16) * 0.05)(D, F)),
            "w_down": _w((lambda *s: torch.randn(*s, dtype=torch.bfloat16) * 0.05)(F, D)),
        }
    _B_in = _B_setup()

    return {
        "A_x": _A_in["x"],
        "A_wqkv": _A_in["wqkv"],
        "A_wo": _A_in["wo"],
        "B_x": _B_in["x"],
        "B_w_gate": _B_in["w_gate"],
        "B_w_up": _B_in["w_up"],
        "B_w_down": _B_in["w_down"],
    }

def reference(A_x, A_wqkv, A_wo, B_x, B_w_gate, B_w_up, B_w_down):
    def _A_ref(x, wqkv, wo):
        B, S, D = x.shape
        H = 32; Dh = D // H
        W, dil = 8, 2
        qkv = (lambda x, *d: x.permute(*d))((x @ wqkv).reshape(B, S, 3, H, Dh), 2, 0, 3, 1, 4)
        q, k, v = qkv[0], qkv[1], qkv[2]
        scale = Dh ** -0.5
        pos = torch.arange(S)
        off = torch.arange(W) * dil
        idx = pos[:, None] - off[None, :]
        mask = idx >= 0
        idx_c = torch.where(mask, idx, 0).reshape(-1)
        kg = k[:, :, idx_c, :].reshape(B, H, S, W, Dh)
        vg = v[:, :, idx_c, :].reshape(B, H, S, W, Dh)
        logits = torch.einsum("bhsd,bhswd->bhsw", q, kg) * scale
        logits = torch.where(mask[None, None, :, :], logits, -1e9)
        attn = _softmax(logits, axis=-1)
        o = torch.einsum("bhsw,bhswd->bhsd", attn, vg)
        return (lambda x, *d: x.permute(*d))(o, 0, 2, 1, 3).reshape(B, S, D) @ wo

    def _B_ref(x, w_gate, w_up, w_down):
        return (_gelu(x @ w_gate) * (x @ w_up)) @ w_down

    x = A_x
    h = x + _A_ref(_layernorm(x, axis=-1), A_wqkv, A_wo)
    h2 = h + _B_ref(_layernorm(h, axis=-1), B_w_gate, B_w_up, B_w_down)
    return h2
```

```asm
; @launch grid=(256,1,1) block=(768,1,1) lds=163840
.amdgcn_target "amdgcn-amd-amdhsa--gfx950"
.text
.globl sequential_preLN__sliding_local_dilated__geglu_ffn__prompt_kernel
.p2align 8
.type sequential_preLN__sliding_local_dilated__geglu_ffn__prompt_kernel,@function
sequential_preLN__sliding_local_dilated__geglu_ffn__prompt_kernel:
s_cmp_ge_u32 s2, 256
s_cbranch_scc1 L_end
s_load_dwordx16 s[16:31], s[0:1], 0
s_load_dwordx4 s[32:35], s[0:1], 64
s_memrealtime s[96:97]
v_and_b32 v1, 63, v0
v_lshrrev_b32 v2, 6, v0
s_nop 0
v_readfirstlane_b32 s99, v2
s_nop 0
s_and_b32 s3, s99, 7
s_and_b32 s57, s2, 7
s_lshr_b32 s15, s2, 3
s_lshr_b32 s6, s15, 3
s_lshl_b32 s56, s57, 2
s_add_u32 s6, s6, s56
s_and_b32 s7, s15, 7
s_and_b32 s4, s3, 3
s_lshr_b32 s5, s3, 2
s_and_b32 s8, s3, 1
s_lshr_b32 s9, s3, 1
s_lshl_b32 s10, s6, 1
s_add_u32 s10, s10, s8
s_lshr_b32 s11, s6, 1
s_and_b32 s12, s15, 15
s_lshl_b32 s13, s11, 2
s_add_u32 s13, s13, s4
v_lshlrev_b32 v2, 4, v1
s_and_b32 s58, s12, 3
s_lshl_b32 s58, s58, 3
s_lshr_b32 s59, 0x160e0c04, s58
s_and_b32 s14, s59, 0xff
s_lshr_b32 s59, 0x15140706, s58
s_and_b32 s59, s59, 0xff
s_lshl_b32 s59, s59, 8
s_or_b32 s14, s14, s59
s_cmp_ge_u32 s99, 8
s_cbranch_scc1 L_helper
s_waitcnt lgkmcnt(0)
s_or_b32 s56, s2, s3
s_cmp_lg_u32 s56, 0
s_cbranch_scc1 L_hello_1
s_mov_b32 s76, s32
s_mov_b32 s77, s33
s_mov_b32 s78, 256
s_mov_b32 s79, 0x00020000
s_lshl_b64 s[96:97], s[96:97], 4
s_or_b32 s96, s96, 8
v_mov_b32 v28, s96
v_mov_b32 v29, s97
v_mov_b32 v26, 0
s_mov_b64 exec, 1
buffer_store_dwordx2 v[28:29], v26, s[76:79], 0 offen sc1
s_mov_b64 exec, -1
L_hello_1:
s_lshl_b32 s59, s2, 3
s_add_u32 s59, s59, s3
v_lshlrev_b32 v4, 7, v1
s_mov_b32 s76, s18
s_mov_b32 s77, s19
s_mov_b32 s78, 1572864
s_mov_b32 s79, 0x00020000
s_mul_i32 s56, s59, 768
s_bfm_b64 exec, 6, 0
buffer_load_dword v6, v4, s[76:79], s56 offen
s_mov_b64 exec, -1
v_lshrrev_b32 v4, 4, v1
v_lshlrev_b32 v14, 10, v4
v_bfe_u32 v5, v1, 2, 2
v_lshl_add_u32 v14, v5, 7, v14
v_lshrrev_b32 v5, 1, v5
v_and_b32 v4, 1, v4
v_lshl_add_u32 v5, v4, 1, v5
v_xor_b32 v5, s4, v5
v_lshl_add_u32 v14, v5, 5, v14
v_and_b32 v5, 3, v1
v_lshl_add_u32 v14, v5, 3, v14
v_add_u32 v15, 65536, v14
v_add_u32 v16, 131072, v14
v_and_b32 v4, 15, v1
v_lshrrev_b32 v5, 4, v1
v_xor_b32 v5, v5, v4
v_lshlrev_b32 v3, 9, v4
v_lshl_add_u32 v3, v5, 4, v3
s_lshl_b32 s56, s5, 14
s_add_u32 s57, s56, 81920
v_add_u32 v21, s57, v3
v_mov_b32 v5, s56
v_cmp_eq_u32 vcc, 0, v4
s_nop 1
v_cndmask_b32 v5, v5, 0, vcc
s_mov_b32 s100, 73728
v_add3_u32 v17, v5, v3, s100
v_xor_b32 v18, 64, v17
v_xor_b32 v22, 64, v21
v_xor_b32 v19, 128, v17
v_xor_b32 v23, 128, v21
v_xor_b32 v20, 192, v17
v_xor_b32 v13, 192, v21
v_lshrrev_b32 v3, 4, v1
v_lshlrev_b32 v5, 2, v3
v_sub_u32 v5, v4, v5
v_mov_b32 v56, 0xf149f2ca
v_subrev_u32 v3, 0, v5
v_and_b32 v57, 0x80000001, v3
v_cmp_eq_u32 vcc, 0, v57
s_nop 1
v_cndmask_b32 v24, v56, 0, vcc
v_cmp_eq_u32 vcc, 0x80000000, v57
s_nop 1
v_cndmask_b32 v28, v56, 0, vcc
v_subrev_u32 v3, 1, v5
v_and_b32 v57, 0x80000001, v3
v_cmp_eq_u32 vcc, 0, v57
s_nop 1
v_cndmask_b32 v25, v56, 0, vcc
v_cmp_eq_u32 vcc, 0x80000000, v57
s_nop 1
v_cndmask_b32 v29, v56, 0, vcc
v_subrev_u32 v3, 2, v5
v_and_b32 v57, 0x80000001, v3
v_cmp_eq_u32 vcc, 0, v57
s_nop 1
v_cndmask_b32 v26, v56, 0, vcc
v_cmp_eq_u32 vcc, 0x80000000, v57
s_nop 1
v_cndmask_b32 v30, v56, 0, vcc
v_subrev_u32 v3, 3, v5
v_and_b32 v57, 0x80000001, v3
v_cmp_eq_u32 vcc, 0, v57
s_nop 1
v_cndmask_b32 v27, v56, 0, vcc
v_cmp_eq_u32 vcc, 0x80000000, v57
s_nop 1
v_cndmask_b32 v31, v56, 0, vcc
s_or_b32 s56, s6, s5
s_cmp_eq_u32 s56, 0
s_cselect_b64 vcc, -1, 0
v_cndmask_b32 v32, v28, v56, vcc
v_cndmask_b32 v33, v29, v56, vcc
v_cndmask_b32 v34, v30, v56, vcc
v_cndmask_b32 v35, v31, v56, vcc
v_lshlrev_b32 v36, 2, v4
s_lshl_b32 s56, s5, 7
s_add_u32 s56, s56, 155648
v_lshl_add_u32 v37, v4, 2, s56
v_lshrrev_b32 v3, 4, v1
v_lshl_add_u32 v38, v3, 4, s56
s_mov_b32 s75, 0x3eb8aa3b
s_mul_i32 s70, s3, 10
v_add_u32 v3, s70, v3
v_lshlrev_b32 v39, 9, v3
v_lshl_add_u32 v39, v4, 4, v39
v_add_u32 v39, 73728, v39
v_lshlrev_b32 v49, 2, v3
v_add_u32 v49, 155648, v49
s_mov_b32 s74, 0x3f803f80
s_mov_b32 s73, 0x3b000000
v_mov_b32 v148, 0
v_mov_b32 v149, 0
v_mov_b32 v150, 0
v_mov_b32 v151, 0
v_mov_b32 v152, 0
v_mov_b32 v153, 0
v_mov_b32 v154, 0
v_mov_b32 v155, 0
v_mov_b32 v156, 0
v_mov_b32 v157, 0
v_mov_b32 v158, 0
v_mov_b32 v159, 0
s_waitcnt lgkmcnt(0)
s_mov_b32 s44, s34
s_mov_b32 s45, s35
s_mov_b32 s46, 16777216
s_mov_b32 s47, 0x00020000
s_mov_b32 s80, s30
s_mov_b32 s81, s31
s_mov_b32 s82, 2097152
s_mov_b32 s83, 0x00020000
s_lshl_b32 s56, s6, 1
s_add_u32 s56, s56, s5
s_lshl_b32 s56, s56, 5
s_lshl_b32 s57, s7, 2
s_add_u32 s56, s56, s57
s_add_u32 s56, s56, s4
s_lshl_b32 s84, s56, 10
s_add_u32 s58, s57, s9
s_lshl_b32 s56, s10, 5
s_add_u32 s56, s56, s58
s_lshl_b32 s85, s56, 10
s_add_u32 s85, s85, 2097152
s_lshl_b32 s90, s56, 8
s_add_u32 s90, s90, 12582912
s_and_b32 s57, s12, 3
s_lshl_b32 s91, s5, 1
s_add_u32 s91, s91, s57
s_add_u32 s92, s91, 1
s_mul_i32 s59, s57, 7
s_and_b32 s93, s14, 0xff
s_sub_u32 s93, s93, s59
s_add_u32 s93, s93, s5
s_lshr_b32 s94, s14, 8
s_sub_u32 s94, s94, s59
s_mul_i32 s56, s13, 112
s_mul_i32 s57, s12, 7
s_add_u32 s56, s56, s57
s_add_u32 s86, s56, s91
s_lshl_b32 s86, s86, 10
s_add_u32 s86, s86, 4194304
s_add_u32 s87, s56, s92
s_lshl_b32 s87, s87, 10
s_add_u32 s87, s87, 4194304
s_add_u32 s88, s56, s93
s_lshl_b32 s88, s88, 10
s_add_u32 s88, s88, 4194304
s_add_u32 s89, s56, s94
s_lshl_b32 s89, s89, 10
s_add_u32 s89, s89, 4194304
s_waitcnt lgkmcnt(0)
s_barrier
ds_read_b128 v[40:43], v39 offset:0
ds_read_b128 v[44:47], v39 offset:256
ds_read_b128 v[50:53], v39 offset:2048
ds_read_b128 v[54:57], v39 offset:2304
ds_read_b128 v[58:61], v39 offset:4096
ds_read_b128 v[160:163], v39 offset:4352
s_waitcnt lgkmcnt(4)
v_dot2c_f32_bf16 v148, s74, v40
v_dot2c_f32_bf16 v150, v40, v40
v_dot2c_f32_bf16 v149, s74, v41
v_dot2c_f32_bf16 v151, v41, v41
v_dot2c_f32_bf16 v148, s74, v42
v_dot2c_f32_bf16 v150, v42, v42
v_dot2c_f32_bf16 v149, s74, v43
v_dot2c_f32_bf16 v151, v43, v43
v_dot2c_f32_bf16 v148, s74, v44
v_dot2c_f32_bf16 v150, v44, v44
v_dot2c_f32_bf16 v149, s74, v45
v_dot2c_f32_bf16 v151, v45, v45
v_dot2c_f32_bf16 v148, s74, v46
v_dot2c_f32_bf16 v150, v46, v46
v_dot2c_f32_bf16 v149, s74, v47
v_dot2c_f32_bf16 v151, v47, v47
s_waitcnt lgkmcnt(2)
v_dot2c_f32_bf16 v152, s74, v50
v_dot2c_f32_bf16 v154, v50, v50
v_dot2c_f32_bf16 v153, s74, v51
v_dot2c_f32_bf16 v155, v51, v51
v_dot2c_f32_bf16 v152, s74, v52
v_dot2c_f32_bf16 v154, v52, v52
v_dot2c_f32_bf16 v153, s74, v53
v_dot2c_f32_bf16 v155, v53, v53
v_dot2c_f32_bf16 v152, s74, v54
v_dot2c_f32_bf16 v154, v54, v54
v_dot2c_f32_bf16 v153, s74, v55
v_dot2c_f32_bf16 v155, v55, v55
v_dot2c_f32_bf16 v152, s74, v56
v_dot2c_f32_bf16 v154, v56, v56
v_dot2c_f32_bf16 v153, s74, v57
v_dot2c_f32_bf16 v155, v57, v57
s_waitcnt lgkmcnt(0)
v_dot2c_f32_bf16 v156, s74, v58
v_dot2c_f32_bf16 v158, v58, v58
v_dot2c_f32_bf16 v157, s74, v59
v_dot2c_f32_bf16 v159, v59, v59
v_dot2c_f32_bf16 v156, s74, v60
v_dot2c_f32_bf16 v158, v60, v60
v_dot2c_f32_bf16 v157, s74, v61
v_dot2c_f32_bf16 v159, v61, v61
v_dot2c_f32_bf16 v156, s74, v160
v_dot2c_f32_bf16 v158, v160, v160
v_dot2c_f32_bf16 v157, s74, v161
v_dot2c_f32_bf16 v159, v161, v161
v_dot2c_f32_bf16 v156, s74, v162
v_dot2c_f32_bf16 v158, v162, v162
v_dot2c_f32_bf16 v157, s74, v163
v_dot2c_f32_bf16 v159, v163, v163
ds_read_b64_tr_b16 v[112:113], v15 offset:0
ds_read_b64_tr_b16 v[114:115], v15 offset:512
ds_read_b128 v[100:103], v17 offset:0
ds_read_b128 v[104:107], v21 offset:0
ds_read_b128 v[108:111], v21 offset:8192
ds_read_b64_tr_b16 v[116:117], v14 offset:57344
ds_read_b64_tr_b16 v[118:119], v14 offset:57856
ds_read_b64_tr_b16 v[120:121], v14 offset:49152
ds_read_b64_tr_b16 v[122:123], v14 offset:49664
s_waitcnt lgkmcnt(4)
v_mfma_f32_16x16x32_bf16 v[64:67], v[112:115], v[100:103], 0
ds_read_b64_tr_b16 v[136:137], v15 offset:4096
v_mfma_f32_16x16x32_bf16 v[68:71], v[112:115], v[104:107], 0
ds_read_b64_tr_b16 v[138:139], v15 offset:4608
v_mfma_f32_16x16x32_bf16 v[72:75], v[112:115], v[108:111], 0
ds_read_b128 v[124:127], v18 offset:0
s_waitcnt lgkmcnt(5)
v_mfma_f32_16x16x32_bf16 v[76:79], v[116:119], v[100:103], 0
ds_read_b128 v[128:131], v22 offset:0
v_mfma_f32_16x16x32_bf16 v[80:83], v[116:119], v[104:107], 0
ds_read_b128 v[132:135], v22 offset:8192
v_mfma_f32_16x16x32_bf16 v[84:87], v[116:119], v[108:111], 0
ds_read_b64_tr_b16 v[140:141], v14 offset:61440
s_waitcnt lgkmcnt(6)
v_mfma_f32_16x16x32_bf16 v[88:91], v[100:103], v[120:123], 0
ds_read_b64_tr_b16 v[142:143], v14 offset:61952
v_mfma_f32_16x16x32_bf16 v[92:95], v[104:107], v[120:123], 0
ds_read_b64_tr_b16 v[144:145], v14 offset:53248
v_mfma_f32_16x16x32_bf16 v[96:99], v[108:111], v[120:123], 0
ds_read_b64_tr_b16 v[146:147], v14 offset:53760
s_waitcnt lgkmcnt(4)
v_mfma_f32_16x16x32_bf16 v[64:67], v[136:139], v[124:127], v[64:67]
v_mfma_f32_16x16x32_bf16 v[68:71], v[136:139], v[128:131], v[68:71]
v_mfma_f32_16x16x32_bf16 v[72:75], v[136:139], v[132:135], v[72:75]
s_waitcnt lgkmcnt(0)
s_barrier
v_mfma_f32_16x16x32_bf16 v[76:79], v[140:143], v[124:127], v[76:79]
ds_read_b64_tr_b16 v[112:113], v14 offset:40960
ds_read_b64_tr_b16 v[114:115], v14 offset:41472
v_mfma_f32_16x16x32_bf16 v[80:83], v[140:143], v[128:131], v[80:83]
ds_read_b128 v[100:103], v19 offset:0
ds_read_b128 v[104:107], v23 offset:0
v_mfma_f32_16x16x32_bf16 v[84:87], v[140:143], v[132:135], v[84:87]
ds_read_b128 v[108:111], v23 offset:8192
ds_read_b64_tr_b16 v[116:117], v14 offset:32768
v_mfma_f32_16x16x32_bf16 v[88:91], v[124:127], v[144:147], v[88:91]
ds_read_b64_tr_b16 v[118:119], v14 offset:33280
ds_read_b64_tr_b16 v[120:121], v14 offset:24576
v_mfma_f32_16x16x32_bf16 v[92:95], v[128:131], v[144:147], v[92:95]
ds_read_b64_tr_b16 v[122:123], v14 offset:25088
v_mfma_f32_16x16x32_bf16 v[96:99], v[132:135], v[144:147], v[96:99]
s_waitcnt lgkmcnt(4)
v_mfma_f32_16x16x32_bf16 v[64:67], v[112:115], v[100:103], v[64:67]
ds_read_b64_tr_b16 v[136:137], v14 offset:45056
v_mfma_f32_16x16x32_bf16 v[68:71], v[112:115], v[104:107], v[68:71]
ds_read_b64_tr_b16 v[138:139], v14 offset:45568
v_mfma_f32_16x16x32_bf16 v[72:75], v[112:115], v[108:111], v[72:75]
ds_read_b128 v[124:127], v20 offset:0
s_waitcnt lgkmcnt(5)
v_mfma_f32_16x16x32_bf16 v[76:79], v[116:119], v[100:103], v[76:79]
ds_read_b128 v[128:131], v13 offset:0
v_mfma_f32_16x16x32_bf16 v[80:83], v[116:119], v[104:107], v[80:83]
ds_read_b128 v[132:135], v13 offset:8192
v_mfma_f32_16x16x32_bf16 v[84:87], v[116:119], v[108:111], v[84:87]
ds_read_b64_tr_b16 v[140:141], v14 offset:36864
s_waitcnt lgkmcnt(6)
v_mfma_f32_16x16x32_bf16 v[88:91], v[100:103], v[120:123], v[88:91]
ds_read_b64_tr_b16 v[142:143], v14 offset:37376
v_mfma_f32_16x16x32_bf16 v[92:95], v[104:107], v[120:123], v[92:95]
ds_read_b64_tr_b16 v[144:145], v14 offset:28672
v_mfma_f32_16x16x32_bf16 v[96:99], v[108:111], v[120:123], v[96:99]
ds_read_b64_tr_b16 v[146:147], v14 offset:29184
s_waitcnt lgkmcnt(4)
v_mfma_f32_16x16x32_bf16 v[64:67], v[136:139], v[124:127], v[64:67]
v_mfma_f32_16x16x32_bf16 v[68:71], v[136:139], v[128:131], v[68:71]
v_mfma_f32_16x16x32_bf16 v[72:75], v[136:139], v[132:135], v[72:75]
s_waitcnt lgkmcnt(0)
s_barrier
v_mfma_f32_16x16x32_bf16 v[76:79], v[140:143], v[124:127], v[76:79]
ds_read_b64_tr_b16 v[112:113], v14 offset:16384
ds_read_b64_tr_b16 v[114:115], v14 offset:16896
v_mfma_f32_16x16x32_bf16 v[80:83], v[140:143], v[128:131], v[80:83]
ds_read_b128 v[100:103], v17 offset:256
ds_read_b128 v[104:107], v21 offset:256
v_mfma_f32_16x16x32_bf16 v[84:87], v[140:143], v[132:135], v[84:87]
ds_read_b128 v[108:111], v21 offset:8448
ds_read_b64_tr_b16 v[116:117], v14 offset:8192
v_mfma_f32_16x16x32_bf16 v[88:91], v[124:127], v[144:147], v[88:91]
ds_read_b64_tr_b16 v[118:119], v14 offset:8704
ds_read_b64_tr_b16 v[120:121], v14 offset:0
v_mfma_f32_16x16x32_bf16 v[92:95], v[128:131], v[144:147], v[92:95]
ds_read_b64_tr_b16 v[122:123], v14 offset:512
v_mfma_f32_16x16x32_bf16 v[96:99], v[132:135], v[144:147], v[96:99]
s_waitcnt lgkmcnt(4)
v_mfma_f32_16x16x32_bf16 v[64:67], v[112:115], v[100:103], v[64:67]
ds_read_b64_tr_b16 v[136:137], v14 offset:20480
v_mfma_f32_16x16x32_bf16 v[68:71], v[112:115], v[104:107], v[68:71]
ds_read_b64_tr_b16 v[138:139], v14 offset:20992
v_mfma_f32_16x16x32_bf16 v[72:75], v[112:115], v[108:111], v[72:75]
ds_read_b128 v[124:127], v18 offset:256
s_waitcnt lgkmcnt(5)
v_mfma_f32_16x16x32_bf16 v[76:79], v[116:119], v[100:103], v[76:79]
ds_read_b128 v[128:131], v22 offset:256
v_mfma_f32_16x16x32_bf16 v[80:83], v[116:119], v[104:107], v[80:83]
ds_read_b128 v[132:135], v22 offset:8448
v_mfma_f32_16x16x32_bf16 v[84:87], v[116:119], v[108:111], v[84:87]
ds_read_b64_tr_b16 v[140:141], v14 offset:12288
s_waitcnt lgkmcnt(6)
v_mfma_f32_16x16x32_bf16 v[88:91], v[100:103], v[120:123], v[88:91]
ds_read_b64_tr_b16 v[142:143], v14 offset:12800
v_mfma_f32_16x16x32_bf16 v[92:95], v[104:107], v[120:123], v[92:95]
ds_read_b64_tr_b16 v[144:145], v14 offset:4096
v_mfma_f32_16x16x32_bf16 v[96:99], v[108:111], v[120:123], v[96:99]
ds_read_b64_tr_b16 v[146:147], v14 offset:4608
s_lshl_b32 s59, s2, 3
s_add_u32 s59, s59, s3
v_lshlrev_b32 v4, 7, v1
s_mov_b32 s76, s20
s_mov_b32 s77, s21
s_mov_b32 s78, 524288
s_mov_b32 s79, 0x00020000
s_mul_i32 s56, s59, 256
s_bfm_b64 exec, 2, 0
buffer_load_dword v6, v4, s[76:79], s56 offen
s_mov_b32 s76, s24
s_mov_b32 s77, s25
s_mov_b32 s78, 1835008
s_mov_b32 s79, 0x00020000
s_mul_i32 s56, s59, 896
s_bfm_b64 exec, 7, 0
buffer_load_dword v6, v4, s[76:79], s56 offen
s_mov_b32 s76, s26
s_mov_b32 s77, s27
s_mov_b32 s78, 1835008
s_mov_b32 s79, 0x00020000
s_mul_i32 s56, s59, 896
s_bfm_b64 exec, 7, 0
buffer_load_dword v6, v4, s[76:79], s56 offen
s_mov_b64 exec, -1
s_waitcnt lgkmcnt(4)
v_mfma_f32_16x16x32_bf16 v[64:67], v[136:139], v[124:127], v[64:67]
v_mfma_f32_16x16x32_bf16 v[68:71], v[136:139], v[128:131], v[68:71]
v_mfma_f32_16x16x32_bf16 v[72:75], v[136:139], v[132:135], v[72:75]
s_waitcnt lgkmcnt(0)
s_barrier
v_mfma_f32_16x16x32_bf16 v[76:79], v[140:143], v[124:127], v[76:79]
ds_read_b64_tr_b16 v[112:113], v15 offset:0
ds_read_b64_tr_b16 v[114:115], v15 offset:512
v_mfma_f32_16x16x32_bf16 v[80:83], v[140:143], v[128:131], v[80:83]
ds_read_b128 v[100:103], v19 offset:256
ds_read_b128 v[104:107], v23 offset:256
v_mfma_f32_16x16x32_bf16 v[84:87], v[140:143], v[132:135], v[84:87]
ds_read_b128 v[108:111], v23 offset:8448
ds_read_b64_tr_b16 v[116:117], v14 offset:57344
v_mfma_f32_16x16x32_bf16 v[88:91], v[124:127], v[144:147], v[88:91]
ds_read_b64_tr_b16 v[118:119], v14 offset:57856
ds_read_b64_tr_b16 v[120:121], v14 offset:49152
v_mfma_f32_16x16x32_bf16 v[92:95], v[128:131], v[144:147], v[92:95]
ds_read_b64_tr_b16 v[122:123], v14 offset:49664
v_mfma_f32_16x16x32_bf16 v[96:99], v[132:135], v[144:147], v[96:99]
s_waitcnt lgkmcnt(4)
v_mfma_f32_16x16x32_bf16 v[64:67], v[112:115], v[100:103], v[64:67]
ds_read_b64_tr_b16 v[136:137], v15 offset:4096
v_mfma_f32_16x16x32_bf16 v[68:71], v[112:115], v[104:107], v[68:71]
ds_read_b64_tr_b16 v[138:139], v15 offset:4608
v_mfma_f32_16x16x32_bf16 v[72:75], v[112:115], v[108:111], v[72:75]
ds_read_b128 v[124:127], v20 offset:256
s_waitcnt lgkmcnt(5)
v_mfma_f32_16x16x32_bf16 v[76:79], v[116:119], v[100:103], v[76:79]
ds_read_b128 v[128:131], v13 offset:256
v_mfma_f32_16x16x32_bf16 v[80:83], v[116:119], v[104:107], v[80:83]
ds_read_b128 v[132:135], v13 offset:8448
v_mfma_f32_16x16x32_bf16 v[84:87], v[116:119], v[108:111], v[84:87]
ds_read_b64_tr_b16 v[140:141], v14 offset:61440
s_waitcnt lgkmcnt(6)
v_mfma_f32_16x16x32_bf16 v[88:91], v[100:103], v[120:123], v[88:91]
ds_read_b64_tr_b16 v[142:143], v14 offset:61952
v_mfma_f32_16x16x32_bf16 v[92:95], v[104:107], v[120:123], v[92:95]
ds_read_b64_tr_b16 v[144:145], v14 offset:53248
v_mfma_f32_16x16x32_bf16 v[96:99], v[108:111], v[120:123], v[96:99]
ds_read_b64_tr_b16 v[146:147], v14 offset:53760
s_waitcnt lgkmcnt(4)
v_mfma_f32_16x16x32_bf16 v[64:67], v[136:139], v[124:127], v[64:67]
v_mfma_f32_16x16x32_bf16 v[68:71], v[136:139], v[128:131], v[68:71]
v_mfma_f32_16x16x32_bf16 v[72:75], v[136:139], v[132:135], v[72:75]
s_waitcnt lgkmcnt(0)
s_barrier
ds_read_b128 v[40:43], v39 offset:40960
ds_read_b128 v[44:47], v39 offset:41216
ds_read_b128 v[50:53], v39 offset:43008
ds_read_b128 v[54:57], v39 offset:43264
ds_read_b128 v[58:61], v39 offset:45056
ds_read_b128 v[160:163], v39 offset:45312
s_waitcnt lgkmcnt(4)
v_dot2c_f32_bf16 v148, s74, v40
v_dot2c_f32_bf16 v150, v40, v40
v_dot2c_f32_bf16 v149, s74, v41
v_dot2c_f32_bf16 v151, v41, v41
v_dot2c_f32_bf16 v148, s74, v42
v_dot2c_f32_bf16 v150, v42, v42
v_dot2c_f32_bf16 v149, s74, v43
v_dot2c_f32_bf16 v151, v43, v43
v_dot2c_f32_bf16 v148, s74, v44
v_dot2c_f32_bf16 v150, v44, v44
v_dot2c_f32_bf16 v149, s74, v45
v_dot2c_f32_bf16 v151, v45, v45
v_dot2c_f32_bf16 v148, s74, v46
v_dot2c_f32_bf16 v150, v46, v46
v_dot2c_f32_bf16 v149, s74, v47
v_dot2c_f32_bf16 v151, v47, v47
s_waitcnt lgkmcnt(2)
v_dot2c_f32_bf16 v152, s74, v50
v_dot2c_f32_bf16 v154, v50, v50
v_dot2c_f32_bf16 v153, s74, v51
v_dot2c_f32_bf16 v155, v51, v51
v_dot2c_f32_bf16 v152, s74, v52
v_dot2c_f32_bf16 v154, v52, v52
v_dot2c_f32_bf16 v153, s74, v53
v_dot2c_f32_bf16 v155, v53, v53
v_dot2c_f32_bf16 v152, s74, v54
v_dot2c_f32_bf16 v154, v54, v54
v_dot2c_f32_bf16 v153, s74, v55
v_dot2c_f32_bf16 v155, v55, v55
v_dot2c_f32_bf16 v152, s74, v56
v_dot2c_f32_bf16 v154, v56, v56
v_dot2c_f32_bf16 v153, s74, v57
v_dot2c_f32_bf16 v155, v57, v57
s_waitcnt lgkmcnt(0)
v_dot2c_f32_bf16 v156, s74, v58
v_dot2c_f32_bf16 v158, v58, v58
v_dot2c_f32_bf16 v157, s74, v59
v_dot2c_f32_bf16 v159, v59, v59
v_dot2c_f32_bf16 v156, s74, v60
v_dot2c_f32_bf16 v158, v60, v60
v_dot2c_f32_bf16 v157, s74, v61
v_dot2c_f32_bf16 v159, v61, v61
v_dot2c_f32_bf16 v156, s74, v160
v_dot2c_f32_bf16 v158, v160, v160
v_dot2c_f32_bf16 v157, s74, v161
v_dot2c_f32_bf16 v159, v161, v161
v_dot2c_f32_bf16 v156, s74, v162
v_dot2c_f32_bf16 v158, v162, v162
v_dot2c_f32_bf16 v157, s74, v163
v_dot2c_f32_bf16 v159, v163, v163
v_add_f32 v148, v148, v149
v_add_f32 v149, v150, v151
v_add_f32 v152, v152, v153
v_add_f32 v153, v154, v155
v_add_f32 v156, v156, v157
v_add_f32 v157, v158, v159
v_add_f32_dpp v148, v148, v148 row_ror:8 row_mask:0xf bank_mask:0xf
v_add_f32_dpp v149, v149, v149 row_ror:8 row_mask:0xf bank_mask:0xf
v_add_f32_dpp v152, v152, v152 row_ror:8 row_mask:0xf bank_mask:0xf
v_add_f32_dpp v153, v153, v153 row_ror:8 row_mask:0xf bank_mask:0xf
v_add_f32_dpp v156, v156, v156 row_ror:8 row_mask:0xf bank_mask:0xf
v_add_f32_dpp v157, v157, v157 row_ror:8 row_mask:0xf bank_mask:0xf
v_add_f32_dpp v148, v148, v148 row_ror:4 row_mask:0xf bank_mask:0xf
v_add_f32_dpp v149, v149, v149 row_ror:4 row_mask:0xf bank_mask:0xf
v_add_f32_dpp v152, v152, v152 row_ror:4 row_mask:0xf bank_mask:0xf
v_add_f32_dpp v153, v153, v153 row_ror:4 row_mask:0xf bank_mask:0xf
v_add_f32_dpp v156, v156, v156 row_ror:4 row_mask:0xf bank_mask:0xf
v_add_f32_dpp v157, v157, v157 row_ror:4 row_mask:0xf bank_mask:0xf
v_add_f32_dpp v148, v148, v148 row_ror:2 row_mask:0xf bank_mask:0xf
v_add_f32_dpp v149, v149, v149 row_ror:2 row_mask:0xf bank_mask:0xf
v_add_f32_dpp v152, v152, v152 row_ror:2 row_mask:0xf bank_mask:0xf
v_add_f32_dpp v153, v153, v153 row_ror:2 row_mask:0xf bank_mask:0xf
v_add_f32_dpp v156, v156, v156 row_ror:2 row_mask:0xf bank_mask:0xf
v_add_f32_dpp v157, v157, v157 row_ror:2 row_mask:0xf bank_mask:0xf
v_add_f32_dpp v148, v148, v148 row_ror:1 row_mask:0xf bank_mask:0xf
v_add_f32_dpp v149, v149, v149 row_ror:1 row_mask:0xf bank_mask:0xf
v_add_f32_dpp v152, v152, v152 row_ror:1 row_mask:0xf bank_mask:0xf
v_add_f32_dpp v153, v153, v153 row_ror:1 row_mask:0xf bank_mask:0xf
v_add_f32_dpp v156, v156, v156 row_ror:1 row_mask:0xf bank_mask:0xf
v_add_f32_dpp v157, v157, v157 row_ror:1 row_mask:0xf bank_mask:0xf
v_mul_f32 v148, s73, v148
v_mul_f32 v152, s73, v152
v_mul_f32 v156, s73, v156
v_mul_f32 v150, v148, v148
v_mul_f32 v154, v152, v152
v_mul_f32 v158, v156, v156
v_fma_f32 v150, v149, s73, -v150
v_fma_f32 v154, v153, s73, -v154
v_fma_f32 v158, v157, s73, -v158
v_max_f32 v150, 0, v150
v_max_f32 v154, 0, v154
v_max_f32 v158, 0, v158
v_add_f32 v150, 0x3727c5ac, v150
v_add_f32 v154, 0x3727c5ac, v154
v_add_f32 v158, 0x3727c5ac, v158
v_rsq_f32 v149, v150
v_rsq_f32 v153, v154
v_rsq_f32 v157, v158
ds_write2_b32 v49, v148, v149 offset0:0 offset1:96
ds_write2_b32 v49, v152, v153 offset0:4 offset1:100
s_mov_b32 exec_hi, 0
ds_write2_b32 v49, v156, v157 offset0:8 offset1:104
s_mov_b64 exec, -1
v_mfma_f32_16x16x32_bf16 v[76:79], v[140:143], v[124:127], v[76:79]
ds_read_b64_tr_b16 v[112:113], v14 offset:24576
ds_read_b64_tr_b16 v[114:115], v14 offset:25088
v_mfma_f32_16x16x32_bf16 v[80:83], v[140:143], v[128:131], v[80:83]
ds_read_b128 v[100:103], v17 offset:40960
ds_read_b128 v[104:107], v21 offset:40960
v_mfma_f32_16x16x32_bf16 v[84:87], v[140:143], v[132:135], v[84:87]
ds_read_b128 v[108:111], v21 offset:49152
ds_read_b64_tr_b16 v[116:117], v14 offset:40960
v_mfma_f32_16x16x32_bf16 v[88:91], v[124:127], v[144:147], v[88:91]
ds_read_b64_tr_b16 v[118:119], v14 offset:41472
ds_read_b64_tr_b16 v[120:121], v14 offset:32768
v_mfma_f32_16x16x32_bf16 v[92:95], v[128:131], v[144:147], v[92:95]
ds_read_b64_tr_b16 v[122:123], v14 offset:33280
v_mfma_f32_16x16x32_bf16 v[96:99], v[132:135], v[144:147], v[96:99]
s_waitcnt lgkmcnt(4)
v_mfma_f32_16x16x32_bf16 v[64:67], v[112:115], v[100:103], v[64:67]
ds_read_b64_tr_b16 v[136:137], v14 offset:28672
v_mfma_f32_16x16x32_bf16 v[68:71], v[112:115], v[104:107], v[68:71]
ds_read_b64_tr_b16 v[138:139], v14 offset:29184
v_mfma_f32_16x16x32_bf16 v[72:75], v[112:115], v[108:111], v[72:75]
ds_read_b128 v[124:127], v18 offset:40960
s_waitcnt lgkmcnt(5)
v_mfma_f32_16x16x32_bf16 v[76:79], v[116:119], v[100:103], v[76:79]
ds_read_b128 v[128:131], v22 offset:40960
v_mfma_f32_16x16x32_bf16 v[80:83], v[116:119], v[104:107], v[80:83]
ds_read_b128 v[132:135], v22 offset:49152
v_mfma_f32_16x16x32_bf16 v[84:87], v[116:119], v[108:111], v[84:87]
ds_read_b64_tr_b16 v[140:141], v14 offset:45056
s_waitcnt lgkmcnt(6)
v_mfma_f32_16x16x32_bf16 v[88:91], v[100:103], v[120:123], v[88:91]
ds_read_b64_tr_b16 v[142:143], v14 offset:45568
v_mfma_f32_16x16x32_bf16 v[92:95], v[104:107], v[120:123], v[92:95]
ds_read_b64_tr_b16 v[144:145], v14 offset:36864
v_mfma_f32_16x16x32_bf16 v[96:99], v[108:111], v[120:123], v[96:99]
ds_read_b64_tr_b16 v[146:147], v14 offset:37376
s_waitcnt lgkmcnt(4)
v_mfma_f32_16x16x32_bf16 v[64:67], v[136:139], v[124:127], v[64:67]
v_mfma_f32_16x16x32_bf16 v[68:71], v[136:139], v[128:131], v[68:71]
v_mfma_f32_16x16x32_bf16 v[72:75], v[136:139], v[132:135], v[72:75]
s_waitcnt lgkmcnt(0)
s_barrier
v_mfma_f32_16x16x32_bf16 v[76:79], v[140:143], v[124:127], v[76:79]
ds_read_b64_tr_b16 v[112:113], v14 offset:16384
ds_read_b64_tr_b16 v[114:115], v14 offset:16896
v_mfma_f32_16x16x32_bf16 v[80:83], v[140:143], v[128:131], v[80:83]
ds_read_b128 v[100:103], v19 offset:40960
ds_read_b128 v[104:107], v23 offset:40960
v_mfma_f32_16x16x32_bf16 v[84:87], v[140:143], v[132:135], v[84:87]
ds_read_b128 v[108:111], v23 offset:49152
ds_read_b64_tr_b16 v[116:117], v14 offset:8192
v_mfma_f32_16x16x32_bf16 v[88:91], v[124:127], v[144:147], v[88:91]
ds_read_b64_tr_b16 v[118:119], v14 offset:8704
ds_read_b64_tr_b16 v[120:121], v14 offset:0
v_mfma_f32_16x16x32_bf16 v[92:95], v[128:131], v[144:147], v[92:95]
ds_read_b64_tr_b16 v[122:123], v14 offset:512
v_mfma_f32_16x16x32_bf16 v[96:99], v[132:135], v[144:147], v[96:99]
s_waitcnt lgkmcnt(4)
v_mfma_f32_16x16x32_bf16 v[64:67], v[112:115], v[100:103], v[64:67]
ds_read_b64_tr_b16 v[136:137], v14 offset:20480
v_mfma_f32_16x16x32_bf16 v[68:71], v[112:115], v[104:107], v[68:71]
ds_read_b64_tr_b16 v[138:139], v14 offset:20992
v_mfma_f32_16x16x32_bf16 v[72:75], v[112:115], v[108:111], v[72:75]
ds_read_b128 v[124:127], v20 offset:40960
s_waitcnt lgkmcnt(5)
v_mfma_f32_16x16x32_bf16 v[76:79], v[116:119], v[100:103], v[76:79]
ds_read_b128 v[128:131], v13 offset:40960
v_mfma_f32_16x16x32_bf16 v[80:83], v[116:119], v[104:107], v[80:83]
ds_read_b128 v[132:135], v13 offset:49152
v_mfma_f32_16x16x32_bf16 v[84:87], v[116:119], v[108:111], v[84:87]
ds_read_b64_tr_b16 v[140:141], v14 offset:12288
s_waitcnt lgkmcnt(6)
v_mfma_f32_16x16x32_bf16 v[88:91], v[100:103], v[120:123], v[88:91]
ds_read_b64_tr_b16 v[142:143], v14 offset:12800
v_mfma_f32_16x16x32_bf16 v[92:95], v[104:107], v[120:123], v[92:95]
ds_read_b64_tr_b16 v[144:145], v14 offset:4096
v_mfma_f32_16x16x32_bf16 v[96:99], v[108:111], v[120:123], v[96:99]
ds_read_b64_tr_b16 v[146:147], v14 offset:4608
s_waitcnt lgkmcnt(4)
v_mfma_f32_16x16x32_bf16 v[64:67], v[136:139], v[124:127], v[64:67]
v_mfma_f32_16x16x32_bf16 v[68:71], v[136:139], v[128:131], v[68:71]
v_mfma_f32_16x16x32_bf16 v[72:75], v[136:139], v[132:135], v[72:75]
s_waitcnt lgkmcnt(0)
s_barrier
v_mfma_f32_16x16x32_bf16 v[76:79], v[140:143], v[124:127], v[76:79]
ds_read_b64_tr_b16 v[112:113], v15 offset:40960
ds_read_b64_tr_b16 v[114:115], v15 offset:41472
v_mfma_f32_16x16x32_bf16 v[80:83], v[140:143], v[128:131], v[80:83]
ds_read_b128 v[100:103], v17 offset:41216
ds_read_b128 v[104:107], v21 offset:41216
v_mfma_f32_16x16x32_bf16 v[84:87], v[140:143], v[132:135], v[84:87]
ds_read_b128 v[108:111], v21 offset:49408
ds_read_b64_tr_b16 v[116:117], v15 offset:32768
v_mfma_f32_16x16x32_bf16 v[88:91], v[124:127], v[144:147], v[88:91]
ds_read_b64_tr_b16 v[118:119], v15 offset:33280
ds_read_b64_tr_b16 v[120:121], v15 offset:24576
v_mfma_f32_16x16x32_bf16 v[92:95], v[128:131], v[144:147], v[92:95]
ds_read_b64_tr_b16 v[122:123], v15 offset:25088
v_mfma_f32_16x16x32_bf16 v[96:99], v[132:135], v[144:147], v[96:99]
s_waitcnt lgkmcnt(4)
v_mfma_f32_16x16x32_bf16 v[64:67], v[112:115], v[100:103], v[64:67]
ds_read_b64_tr_b16 v[136:137], v15 offset:45056
v_mfma_f32_16x16x32_bf16 v[68:71], v[112:115], v[104:107], v[68:71]
ds_read_b64_tr_b16 v[138:139], v15 offset:45568
v_mfma_f32_16x16x32_bf16 v[72:75], v[112:115], v[108:111], v[72:75]
ds_read_b128 v[124:127], v18 offset:41216
s_waitcnt lgkmcnt(5)
v_mfma_f32_16x16x32_bf16 v[76:79], v[116:119], v[100:103], v[76:79]
ds_read_b128 v[128:131], v22 offset:41216
v_mfma_f32_16x16x32_bf16 v[80:83], v[116:119], v[104:107], v[80:83]
ds_read_b128 v[132:135], v22 offset:49408
v_mfma_f32_16x16x32_bf16 v[84:87], v[116:119], v[108:111], v[84:87]
ds_read_b64_tr_b16 v[140:141], v15 offset:36864
s_waitcnt lgkmcnt(6)
v_mfma_f32_16x16x32_bf16 v[88:91], v[100:103], v[120:123], v[88:91]
ds_read_b64_tr_b16 v[142:143], v15 offset:37376
v_mfma_f32_16x16x32_bf16 v[92:95], v[104:107], v[120:123], v[92:95]
ds_read_b64_tr_b16 v[144:145], v15 offset:28672
v_mfma_f32_16x16x32_bf16 v[96:99], v[108:111], v[120:123], v[96:99]
ds_read_b64_tr_b16 v[146:147], v15 offset:29184
s_waitcnt lgkmcnt(4)
v_mfma_f32_16x16x32_bf16 v[64:67], v[136:139], v[124:127], v[64:67]
v_mfma_f32_16x16x32_bf16 v[68:71], v[136:139], v[128:131], v[68:71]
v_mfma_f32_16x16x32_bf16 v[72:75], v[136:139], v[132:135], v[72:75]
s_waitcnt lgkmcnt(0)
s_barrier
v_mfma_f32_16x16x32_bf16 v[76:79], v[140:143], v[124:127], v[76:79]
ds_read_b64_tr_b16 v[112:113], v15 offset:16384
ds_read_b64_tr_b16 v[114:115], v15 offset:16896
v_mfma_f32_16x16x32_bf16 v[80:83], v[140:143], v[128:131], v[80:83]
ds_read_b128 v[100:103], v19 offset:41216
ds_read_b128 v[104:107], v23 offset:41216
v_mfma_f32_16x16x32_bf16 v[84:87], v[140:143], v[132:135], v[84:87]
ds_read_b128 v[108:111], v23 offset:49408
ds_read_b64_tr_b16 v[116:117], v14 offset:24576
v_mfma_f32_16x16x32_bf16 v[88:91], v[124:127], v[144:147], v[88:91]
ds_read_b64_tr_b16 v[118:119], v14 offset:25088
ds_read_b64_tr_b16 v[120:121], v15 offset:8192
v_mfma_f32_16x16x32_bf16 v[92:95], v[128:131], v[144:147], v[92:95]
ds_read_b64_tr_b16 v[122:123], v15 offset:8704
v_mfma_f32_16x16x32_bf16 v[96:99], v[132:135], v[144:147], v[96:99]
s_waitcnt lgkmcnt(4)
v_mfma_f32_16x16x32_bf16 v[64:67], v[112:115], v[100:103], v[64:67]
ds_read_b64_tr_b16 v[136:137], v15 offset:20480
v_mfma_f32_16x16x32_bf16 v[68:71], v[112:115], v[104:107], v[68:71]
ds_read_b64_tr_b16 v[138:139], v15 offset:20992
v_mfma_f32_16x16x32_bf16 v[72:75], v[112:115], v[108:111], v[72:75]
ds_read_b128 v[124:127], v20 offset:41216
s_waitcnt lgkmcnt(5)
v_mfma_f32_16x16x32_bf16 v[76:79], v[116:119], v[100:103], v[76:79]
ds_read_b128 v[128:131], v13 offset:41216
v_mfma_f32_16x16x32_bf16 v[80:83], v[116:119], v[104:107], v[80:83]
ds_read_b128 v[132:135], v13 offset:49408
v_mfma_f32_16x16x32_bf16 v[84:87], v[116:119], v[108:111], v[84:87]
ds_read_b64_tr_b16 v[140:141], v14 offset:28672
s_waitcnt lgkmcnt(6)
v_mfma_f32_16x16x32_bf16 v[88:91], v[100:103], v[120:123], v[88:91]
ds_read_b64_tr_b16 v[142:143], v14 offset:29184
v_mfma_f32_16x16x32_bf16 v[92:95], v[104:107], v[120:123], v[92:95]
ds_read_b64_tr_b16 v[144:145], v15 offset:12288
v_mfma_f32_16x16x32_bf16 v[96:99], v[108:111], v[120:123], v[96:99]
ds_read_b64_tr_b16 v[146:147], v15 offset:12800
s_waitcnt lgkmcnt(4)
v_mfma_f32_16x16x32_bf16 v[64:67], v[136:139], v[124:127], v[64:67]
v_mfma_f32_16x16x32_bf16 v[68:71], v[136:139], v[128:131], v[68:71]
v_mfma_f32_16x16x32_bf16 v[72:75], v[136:139], v[132:135], v[72:75]
s_waitcnt lgkmcnt(2)
v_mfma_f32_16x16x32_bf16 v[76:79], v[140:143], v[124:127], v[76:79]
v_mfma_f32_16x16x32_bf16 v[80:83], v[140:143], v[128:131], v[80:83]
v_mfma_f32_16x16x32_bf16 v[84:87], v[140:143], v[132:135], v[84:87]
s_waitcnt lgkmcnt(0)
v_mfma_f32_16x16x32_bf16 v[88:91], v[124:127], v[144:147], v[88:91]
v_mfma_f32_16x16x32_bf16 v[92:95], v[128:131], v[144:147], v[92:95]
v_mfma_f32_16x16x32_bf16 v[96:99], v[132:135], v[144:147], v[96:99]
s_waitcnt lgkmcnt(0)
s_barrier
s_nop 3
ds_bpermute_b32 v48, v36, v88
ds_read2_b32 v[50:51], v37 offset0:0 offset1:96
ds_read2_b32 v[52:53], v37 offset0:16 offset1:112
ds_read2_b32 v[54:55], v37 offset0:32 offset1:128
ds_read_b128 v[100:103], v38 offset:0
ds_read_b128 v[104:107], v38 offset:384
ds_read_b128 v[108:111], v38 offset:64
ds_read_b128 v[112:115], v38 offset:448
ds_read_b128 v[116:119], v38 offset:128
ds_read_b128 v[120:123], v38 offset:512
v_mov_b32 v4, 156672
ds_read_b128 v[124:127], v4
v_mov_b32_dpp v40, v64 row_newbcast:0 row_mask:0xf bank_mask:0xf
v_mov_b32_dpp v44, v76 row_newbcast:0 row_mask:0xf bank_mask:0xf
v_mov_b32_dpp v41, v65 row_newbcast:0 row_mask:0xf bank_mask:0xf
v_mov_b32_dpp v45, v77 row_newbcast:0 row_mask:0xf bank_mask:0xf
v_mov_b32_dpp v42, v66 row_newbcast:0 row_mask:0xf bank_mask:0xf
v_mov_b32_dpp v46, v78 row_newbcast:0 row_mask:0xf bank_mask:0xf
v_mov_b32_dpp v43, v67 row_newbcast:0 row_mask:0xf bank_mask:0xf
v_mov_b32_dpp v47, v79 row_newbcast:0 row_mask:0xf bank_mask:0xf
s_waitcnt lgkmcnt(0)
v_pk_fma_f32 v[64:65], v[50:51], v[40:41], v[64:65] op_sel_hi:[0,1,1] neg_lo:[1,0,0] neg_hi:[1,0,0]
v_pk_fma_f32 v[66:67], v[50:51], v[42:43], v[66:67] op_sel_hi:[0,1,1] neg_lo:[1,0,0] neg_hi:[1,0,0]
v_pk_mul_f32 v[64:65], v[64:65], v[50:51] op_sel:[0,1] op_sel_hi:[1,1]
v_pk_mul_f32 v[66:67], v[66:67], v[50:51] op_sel:[0,1] op_sel_hi:[1,1]
v_cvt_pk_bf16_f32 v136, v64, v65
v_cvt_pk_bf16_f32 v137, v66, v67
v_pk_fma_f32 v[68:69], v[52:53], v[40:41], v[68:69] op_sel_hi:[0,1,1] neg_lo:[1,0,0] neg_hi:[1,0,0]
v_pk_fma_f32 v[70:71], v[52:53], v[42:43], v[70:71] op_sel_hi:[0,1,1] neg_lo:[1,0,0] neg_hi:[1,0,0]
v_pk_mul_f32 v[68:69], v[68:69], v[52:53] op_sel:[0,1] op_sel_hi:[1,1]
v_pk_mul_f32 v[70:71], v[70:71], v[52:53] op_sel:[0,1] op_sel_hi:[1,1]
v_cvt_pk_bf16_f32 v138, v68, v69
v_cvt_pk_bf16_f32 v139, v70, v71
v_pk_fma_f32 v[80:81], v[52:53], v[44:45], v[80:81] op_sel_hi:[0,1,1] neg_lo:[1,0,0] neg_hi:[1,0,0]
v_pk_fma_f32 v[82:83], v[52:53], v[46:47], v[82:83] op_sel_hi:[0,1,1] neg_lo:[1,0,0] neg_hi:[1,0,0]
v_pk_mul_f32 v[80:81], v[80:81], v[52:53] op_sel:[0,1] op_sel_hi:[1,1]
v_pk_mul_f32 v[82:83], v[82:83], v[52:53] op_sel:[0,1] op_sel_hi:[1,1]
v_cvt_pk_bf16_f32 v144, v80, v81
v_cvt_pk_bf16_f32 v145, v82, v83
v_pk_fma_f32 v[72:73], v[54:55], v[40:41], v[72:73] op_sel_hi:[0,1,1] neg_lo:[1,0,0] neg_hi:[1,0,0]
v_pk_fma_f32 v[74:75], v[54:55], v[42:43], v[74:75] op_sel_hi:[0,1,1] neg_lo:[1,0,0] neg_hi:[1,0,0]
v_pk_mul_f32 v[72:73], v[72:73], v[54:55] op_sel:[0,1] op_sel_hi:[1,1]
v_pk_mul_f32 v[74:75], v[74:75], v[54:55] op_sel:[0,1] op_sel_hi:[1,1]
v_cvt_pk_bf16_f32 v140, v72, v73
v_cvt_pk_bf16_f32 v141, v74, v75
v_pk_fma_f32 v[84:85], v[54:55], v[44:45], v[84:85] op_sel_hi:[0,1,1] neg_lo:[1,0,0] neg_hi:[1,0,0]
v_pk_fma_f32 v[86:87], v[54:55], v[46:47], v[86:87] op_sel_hi:[0,1,1] neg_lo:[1,0,0] neg_hi:[1,0,0]
v_pk_mul_f32 v[84:85], v[84:85], v[54:55] op_sel:[0,1] op_sel_hi:[1,1]
v_pk_mul_f32 v[86:87], v[86:87], v[54:55] op_sel:[0,1] op_sel_hi:[1,1]
v_cvt_pk_bf16_f32 v146, v84, v85
v_cvt_pk_bf16_f32 v147, v86, v87
v_mfma_f32_16x16x16_bf16 v[64:67], v[136:137], v[144:145], 0
v_mfma_f32_16x16x16_bf16 v[68:71], v[138:139], v[144:145], 0
v_mfma_f32_16x16x16_bf16 v[72:75], v[138:139], v[146:147], 0
v_mfma_f32_16x16x16_bf16 v[76:79], v[140:141], v[146:147], 0
v_pk_fma_f32 v[88:89], v[100:101], v[48:49], v[88:89] op_sel_hi:[1,0,1] neg_lo:[1,0,0] neg_hi:[1,0,0]
v_pk_fma_f32 v[90:91], v[102:103], v[48:49], v[90:91] op_sel_hi:[1,0,1] neg_lo:[1,0,0] neg_hi:[1,0,0]
v_pk_mul_f32 v[88:89], v[88:89], v[104:105]
v_pk_mul_f32 v[90:91], v[90:91], v[106:107]
v_cvt_pk_bf16_f32 v58, v88, v89
v_cvt_pk_bf16_f32 v59, v90, v91
v_pk_fma_f32 v[92:93], v[108:109], v[48:49], v[92:93] op_sel_hi:[1,0,1] neg_lo:[1,0,0] neg_hi:[1,0,0]
v_pk_fma_f32 v[94:95], v[110:111], v[48:49], v[94:95] op_sel_hi:[1,0,1] neg_lo:[1,0,0] neg_hi:[1,0,0]
v_pk_mul_f32 v[92:93], v[92:93], v[112:113]
v_pk_mul_f32 v[94:95], v[94:95], v[114:115]
v_cvt_pk_bf16_f32 v60, v92, v93
v_cvt_pk_bf16_f32 v61, v94, v95
v_pk_fma_f32 v[96:97], v[116:117], v[48:49], v[96:97] op_sel_hi:[1,0,1] neg_lo:[1,0,0] neg_hi:[1,0,0]
v_pk_fma_f32 v[98:99], v[118:119], v[48:49], v[98:99] op_sel_hi:[1,0,1] neg_lo:[1,0,0] neg_hi:[1,0,0]
v_pk_mul_f32 v[96:97], v[96:97], v[120:121]
v_pk_mul_f32 v[98:99], v[98:99], v[122:123]
v_cvt_pk_bf16_f32 v62, v96, v97
v_cvt_pk_bf16_f32 v63, v98, v99
v_pk_fma_f32 v[64:65], v[64:65], s[74:75], v[32:33] op_sel:[0,1,0] op_sel_hi:[1,1,1]
v_pk_fma_f32 v[68:69], v[68:69], s[74:75], v[24:25] op_sel:[0,1,0] op_sel_hi:[1,1,1]
v_pk_fma_f32 v[66:67], v[66:67], s[74:75], v[34:35] op_sel:[0,1,0] op_sel_hi:[1,1,1]
v_pk_fma_f32 v[70:71], v[70:71], s[74:75], v[26:27] op_sel:[0,1,0] op_sel_hi:[1,1,1]
v_pk_fma_f32 v[72:73], v[72:73], s[74:75], v[28:29] op_sel:[0,1,0] op_sel_hi:[1,1,1]
v_pk_fma_f32 v[76:77], v[76:77], s[74:75], v[24:25] op_sel:[0,1,0] op_sel_hi:[1,1,1]
v_pk_fma_f32 v[74:75], v[74:75], s[74:75], v[30:31] op_sel:[0,1,0] op_sel_hi:[1,1,1]
v_pk_fma_f32 v[78:79], v[78:79], s[74:75], v[26:27] op_sel:[0,1,0] op_sel_hi:[1,1,1]
v_max3_f32 v40, v64, v65, v66
v_max3_f32 v41, v72, v73, v74
v_max3_f32 v40, v40, v67, v68
v_max3_f32 v41, v41, v75, v76
v_max3_f32 v40, v40, v69, v70
v_max3_f32 v41, v41, v77, v78
v_max_f32 v40, v40, v71
v_max_f32 v41, v41, v79
v_mov_b32 v42, v40
v_mov_b32 v43, v41
s_nop 0
v_permlane16_swap_b32 v40, v42
v_permlane16_swap_b32 v41, v43
v_max_f32 v40, v40, v42
v_max_f32 v41, v41, v43
v_mov_b32 v42, v40
v_mov_b32 v43, v41
s_nop 0
v_permlane32_swap_b32 v40, v42
v_permlane32_swap_b32 v41, v43
v_max_f32 v40, v40, v42
v_max_f32 v41, v41, v43
v_pk_add_f32 v[64:65], v[64:65], v[40:41] op_sel:[0,0] op_sel_hi:[1,0] neg_lo:[0,1] neg_hi:[0,1]
v_pk_add_f32 v[66:67], v[66:67], v[40:41] op_sel:[0,0] op_sel_hi:[1,0] neg_lo:[0,1] neg_hi:[0,1]
v_pk_add_f32 v[68:69], v[68:69], v[40:41] op_sel:[0,0] op_sel_hi:[1,0] neg_lo:[0,1] neg_hi:[0,1]
v_pk_add_f32 v[70:71], v[70:71], v[40:41] op_sel:[0,0] op_sel_hi:[1,0] neg_lo:[0,1] neg_hi:[0,1]
v_pk_add_f32 v[72:73], v[72:73], v[40:41] op_sel:[0,1] op_sel_hi:[1,1] neg_lo:[0,1] neg_hi:[0,1]
v_pk_add_f32 v[74:75], v[74:75], v[40:41] op_sel:[0,1] op_sel_hi:[1,1] neg_lo:[0,1] neg_hi:[0,1]
v_pk_add_f32 v[76:77], v[76:77], v[40:41] op_sel:[0,1] op_sel_hi:[1,1] neg_lo:[0,1] neg_hi:[0,1]
v_pk_add_f32 v[78:79], v[78:79], v[40:41] op_sel:[0,1] op_sel_hi:[1,1] neg_lo:[0,1] neg_hi:[0,1]
v_exp_f32 v64, v64
v_exp_f32 v65, v65
v_exp_f32 v66, v66
v_exp_f32 v67, v67
v_exp_f32 v68, v68
v_exp_f32 v69, v69
v_exp_f32 v70, v70
v_exp_f32 v71, v71
v_exp_f32 v72, v72
v_exp_f32 v73, v73
v_exp_f32 v74, v74
v_exp_f32 v75, v75
v_exp_f32 v76, v76
v_exp_f32 v77, v77
v_exp_f32 v78, v78
v_exp_f32 v79, v79
v_readfirstlane_b32 s96, v124
v_readfirstlane_b32 s97, v125
v_readfirstlane_b32 s98, v126
v_pk_add_f32 v[116:117], v[64:65], v[66:67]
v_pk_add_f32 v[118:119], v[68:69], v[70:71]
v_pk_add_f32 v[120:121], v[72:73], v[74:75]
v_pk_add_f32 v[122:123], v[76:77], v[78:79]
v_pk_add_f32 v[116:117], v[116:117], v[118:119]
v_pk_add_f32 v[120:121], v[120:121], v[122:123]
v_add_f32 v44, v116, v117
v_add_f32 v45, v120, v121
v_mov_b32 v42, v44
v_mov_b32 v43, v45
s_nop 0
v_permlane16_swap_b32 v44, v42
v_permlane16_swap_b32 v45, v43
v_add_f32 v44, v44, v42
v_add_f32 v45, v45, v43
v_mov_b32 v42, v44
v_mov_b32 v43, v45
s_nop 0
v_permlane32_swap_b32 v44, v42
v_permlane32_swap_b32 v45, v43
v_add_f32 v44, v44, v42
v_add_f32 v45, v45, v43
v_rcp_f32 v44, v44
v_rcp_f32 v45, v45
s_nop 0
v_pk_mul_f32 v[64:65], v[64:65], v[44:45] op_sel:[0,0] op_sel_hi:[1,0]
v_pk_mul_f32 v[66:67], v[66:67], v[44:45] op_sel:[0,0] op_sel_hi:[1,0]
v_pk_mul_f32 v[68:69], v[68:69], v[44:45] op_sel:[0,0] op_sel_hi:[1,0]
v_pk_mul_f32 v[70:71], v[70:71], v[44:45] op_sel:[0,0] op_sel_hi:[1,0]
v_cvt_pk_bf16_f32 v100, v64, v65
v_cvt_pk_bf16_f32 v101, v66, v67
v_cvt_pk_bf16_f32 v102, v68, v69
v_cvt_pk_bf16_f32 v103, v70, v71
v_pk_mul_f32 v[72:73], v[72:73], v[44:45] op_sel:[0,1] op_sel_hi:[1,1]
v_pk_mul_f32 v[74:75], v[74:75], v[44:45] op_sel:[0,1] op_sel_hi:[1,1]
v_pk_mul_f32 v[76:77], v[76:77], v[44:45] op_sel:[0,1] op_sel_hi:[1,1]
v_pk_mul_f32 v[78:79], v[78:79], v[44:45] op_sel:[0,1] op_sel_hi:[1,1]
v_cvt_pk_bf16_f32 v104, v72, v73
v_cvt_pk_bf16_f32 v105, v74, v75
v_cvt_pk_bf16_f32 v106, v76, v77
v_cvt_pk_bf16_f32 v107, v78, v79
v_mfma_f32_16x16x32_bf16 v[108:111], v[58:61], v[100:103], 0
s_nop 0
v_mfma_f32_16x16x32_bf16 v[112:115], v[60:63], v[104:107], 0
s_lshl_b32 s56, s6, 1
s_add_u32 s56, s56, s5
s_lshl_b32 s56, s56, 5
s_lshl_b32 s57, s7, 2
s_add_u32 s56, s56, s57
s_add_u32 s56, s56, s4
s_lshl_b32 s56, s56, 10
v_cvt_pk_bf16_f32 v40, v108, v109
v_cvt_pk_bf16_f32 v41, v110, v111
v_cvt_pk_bf16_f32 v42, v112, v113
v_cvt_pk_bf16_f32 v43, v114, v115
s_nop 0
v_permlane16_swap_b32 v40, v42
v_permlane16_swap_b32 v41, v43
buffer_store_dwordx4 v[40:43], v2, s[44:47], s56 offen sc1
s_and_b32 s57, s6, 1
s_lshl_b32 s57, s57, 1
s_add_u32 s57, s57, s5
s_lshl_b32 s57, s57, 3
s_add_u32 s57, s57, s7
s_lshl_b32 s57, s57, 2
s_add_u32 s57, s57, s4
s_add_u32 s56, s11, 0
s_lshl_b32 s56, s56, 10
s_lshl_b32 s57, s57, 3
s_add_u32 s56, s56, s57
s_add_u32 s56, s56, 14155776
v_mov_b32 v4, s96
v_mov_b32 v5, s97
v_mov_b32 v3, 0
s_waitcnt vmcnt(0)
s_mov_b64 exec, 1
s_cmp_eq_u32 s98, 0
s_cbranch_scc1 L_pubslow_2
buffer_store_dwordx2 v[4:5], v3, s[44:47], s56 offen
s_branch L_pubdone_3
L_pubslow_2:
buffer_store_dwordx2 v[4:5], v3, s[44:47], s56 offen sc1
L_pubdone_3:
s_mov_b64 exec, -1
v_bfe_u32 v4, v1, 2, 2
v_lshlrev_b32 v14, 7, v4
v_lshrrev_b32 v4, 1, v4
v_lshl_add_u32 v14, v4, 6, v14
v_bfe_u32 v4, v1, 4, 1
v_lshl_add_u32 v14, v4, 5, v14
v_and_b32 v4, 3, v1
v_lshl_add_u32 v14, v4, 3, v14
v_lshrrev_b32 v4, 5, v1
v_lshl_add_u32 v14, v4, 10, v14
s_lshl_b32 s56, s9, 12
s_lshl_b32 s57, s9, 5
v_add_u32 v14, s56, v14
v_xor_b32 v14, s57, v14
v_xor_b32 v15, 64, v14
v_add_u32 v16, 65536, v14
v_add_u32 v17, 65536, v15
v_add_u32 v18, 131072, v14
v_add_u32 v19, 131072, v15
v_and_b32 v4, 31, v1
s_lshl_b32 s56, s8, 5
v_add_u32 v4, s56, v4
v_lshlrev_b32 v20, 7, v4
v_and_b32 v4, 7, v4
s_lshl_b32 s56, s9, 1
v_xor_b32 v4, s56, v4
v_lshl_add_u32 v20, v4, 4, v20
v_lshrrev_b32 v4, 5, v1
v_lshl_add_u32 v20, v4, 3, v20
v_mov_b32 v21, v20
v_add_u32 v20, 147456, v20
s_and_b32 s57, s6, 1
s_lshl_b32 s57, s57, 1
s_add_u32 s57, s57, s8
s_lshl_b32 s57, s57, 2
s_add_u32 s57, s57, s9
s_lshl_b32 s57, s57, 6
s_lshl_b32 s56, s11, 10
s_add_u32 s56, s56, s57
s_add_u32 s56, s56, 14155776
v_and_b32 v4, 7, v1
v_lshlrev_b32 v4, 3, v4
s_mov_b32 s57, 0
L_poll_4:
buffer_load_dwordx2 v[6:7], v4, s[44:47], s56 offen sc1
s_add_u32 s57, s57, 1
s_cmp_gt_u32 s57, 0x40000
s_cbranch_scc1 L_polld_5
s_waitcnt vmcnt(0)
v_cmp_ne_u64 vcc, s[96:97], v[6:7]
s_cbranch_vccnz L_poll_4
L_polld_5:
s_waitcnt vmcnt(0)
s_cmp_lg_u32 s98, 0
s_cbranch_scc1 L_noacq_6
buffer_inv sc1
s_waitcnt vmcnt(0)
L_noacq_6:
s_lshl_b32 s56, s10, 5
s_lshl_b32 s57, s9, 3
s_add_u32 s56, s56, s57
s_lshl_b32 s56, s56, 10
s_add_u32 s57, s56, 4096
buffer_load_dwordx4 v[112:115], v2, s[44:47], s56 offen offset:0 sc1
buffer_load_dwordx4 v[116:119], v2, s[44:47], s56 offen offset:1024 sc1
buffer_load_dwordx4 v[120:123], v2, s[44:47], s56 offen offset:2048 sc1
buffer_load_dwordx4 v[124:127], v2, s[44:47], s56 offen offset:3072 sc1
buffer_load_dwordx4 v[128:131], v2, s[44:47], s57 offen offset:0 sc1
buffer_load_dwordx4 v[132:135], v2, s[44:47], s57 offen offset:1024 sc1
buffer_load_dwordx4 v[136:139], v2, s[44:47], s57 offen offset:2048 sc1
buffer_load_dwordx4 v[140:143], v2, s[44:47], s57 offen offset:3072 sc1
s_barrier
v_xor_b32 v4, 16, v20
ds_read_b64 v[28:29], v20
ds_read_b64 v[30:31], v4
ds_read_b64_tr_b16 v[96:97], v14 offset:0
ds_read_b64_tr_b16 v[98:99], v14 offset:512
ds_read_b64_tr_b16 v[100:101], v15 offset:0
ds_read_b64_tr_b16 v[102:103], v15 offset:512
ds_read_b64_tr_b16 v[104:105], v14 offset:2048
ds_read_b64_tr_b16 v[106:107], v14 offset:2560
ds_read_b64_tr_b16 v[108:109], v15 offset:2048
ds_read_b64_tr_b16 v[110:111], v15 offset:2560
s_waitcnt vmcnt(7)
s_waitcnt lgkmcnt(6)
v_mfma_f32_32x32x16_bf16 v[64:79], v[96:99], v[112:115], 0
ds_read_b64_tr_b16 v[96:97], v14 offset:32768
ds_read_b64_tr_b16 v[98:99], v14 offset:33280
s_waitcnt lgkmcnt(6)
v_mfma_f32_32x32x16_bf16 v[80:95], v[100:103], v[112:115], 0
ds_read_b64_tr_b16 v[100:101], v15 offset:32768
ds_read_b64_tr_b16 v[102:103], v15 offset:33280
s_waitcnt vmcnt(6)
s_waitcnt lgkmcnt(6)
v_mfma_f32_32x32x16_bf16 v[64:79], v[104:107], v[116:119], v[64:79]
ds_read_b64_tr_b16 v[104:105], v14 offset:34816
ds_read_b64_tr_b16 v[106:107], v14 offset:35328
s_waitcnt lgkmcnt(6)
v_mfma_f32_32x32x16_bf16 v[80:95], v[108:111], v[116:119], v[80:95]
ds_read_b64_tr_b16 v[108:109], v15 offset:34816
ds_read_b64_tr_b16 v[110:111], v15 offset:35328
s_waitcnt vmcnt(5)
s_waitcnt lgkmcnt(6)
v_mfma_f32_32x32x16_bf16 v[64:79], v[96:99], v[120:123], v[64:79]
ds_read_b64_tr_b16 v[96:97], v14 offset:49152
ds_read_b64_tr_b16 v[98:99], v14 offset:49664
s_waitcnt lgkmcnt(6)
v_mfma_f32_32x32x16_bf16 v[80:95], v[100:103], v[120:123], v[80:95]
ds_read_b64_tr_b16 v[100:101], v15 offset:49152
ds_read_b64_tr_b16 v[102:103], v15 offset:49664
s_waitcnt vmcnt(4)
s_waitcnt lgkmcnt(6)
v_mfma_f32_32x32x16_bf16 v[64:79], v[104:107], v[124:127], v[64:79]
ds_read_b64_tr_b16 v[104:105], v14 offset:51200
ds_read_b64_tr_b16 v[106:107], v14 offset:51712
s_waitcnt lgkmcnt(6)
v_mfma_f32_32x32x16_bf16 v[80:95], v[108:111], v[124:127], v[80:95]
ds_read_b64_tr_b16 v[108:109], v15 offset:51200
ds_read_b64_tr_b16 v[110:111], v15 offset:51712
s_waitcnt vmcnt(3)
s_waitcnt lgkmcnt(6)
v_mfma_f32_32x32x16_bf16 v[64:79], v[96:99], v[128:131], v[64:79]
ds_read_b64_tr_b16 v[96:97], v14 offset:16384
ds_read_b64_tr_b16 v[98:99], v14 offset:16896
s_waitcnt lgkmcnt(6)
v_mfma_f32_32x32x16_bf16 v[80:95], v[100:103], v[128:131], v[80:95]
ds_read_b64_tr_b16 v[100:101], v15 offset:16384
ds_read_b64_tr_b16 v[102:103], v15 offset:16896
s_waitcnt vmcnt(2)
s_waitcnt lgkmcnt(6)
v_mfma_f32_32x32x16_bf16 v[64:79], v[104:107], v[132:135], v[64:79]
ds_read_b64_tr_b16 v[104:105], v14 offset:18432
ds_read_b64_tr_b16 v[106:107], v14 offset:18944
s_waitcnt lgkmcnt(6)
v_mfma_f32_32x32x16_bf16 v[80:95], v[108:111], v[132:135], v[80:95]
ds_read_b64_tr_b16 v[108:109], v15 offset:18432
ds_read_b64_tr_b16 v[110:111], v15 offset:18944
s_waitcnt vmcnt(1)
s_waitcnt lgkmcnt(6)
v_mfma_f32_32x32x16_bf16 v[64:79], v[96:99], v[136:139], v[64:79]
s_waitcnt lgkmcnt(4)
v_mfma_f32_32x32x16_bf16 v[80:95], v[100:103], v[136:139], v[80:95]
s_waitcnt vmcnt(0)
s_waitcnt lgkmcnt(2)
v_mfma_f32_32x32x16_bf16 v[64:79], v[104:107], v[140:143], v[64:79]
s_waitcnt lgkmcnt(0)
v_mfma_f32_32x32x16_bf16 v[80:95], v[108:111], v[140:143], v[80:95]
v_lshlrev_b32 v32, 16, v28
v_and_b32 v33, 0xffff0000, v28
v_lshlrev_b32 v34, 16, v29
v_and_b32 v35, 0xffff0000, v29
v_lshlrev_b32 v36, 16, v30
v_and_b32 v37, 0xffff0000, v30
v_lshlrev_b32 v38, 16, v31
v_and_b32 v39, 0xffff0000, v31
s_barrier
s_xor_b32 s56, s3, 2
s_lshl_b32 s56, s56, 11
s_add_u32 s56, s56, 0
v_add_u32 v4, s56, v2
ds_write_b128 v4, v[72:75]
ds_write_b128 v4, v[76:79] offset:1024
s_xor_b32 s56, s3, 4
s_lshl_b32 s56, s56, 11
s_add_u32 s56, s56, 32768
v_add_u32 v4, s56, v2
ds_write_b128 v4, v[80:83]
ds_write_b128 v4, v[84:87] offset:1024
s_xor_b32 s56, s3, 6
s_lshl_b32 s56, s56, 11
s_add_u32 s56, s56, 49152
v_add_u32 v4, s56, v2
ds_write_b128 v4, v[88:91]
ds_write_b128 v4, v[92:95] offset:1024
s_lshl_b32 s56, s3, 11
v_add_u32 v3, s56, v2
v_add_u32 v4, 0, v3
v_add_u32 v5, 32768, v3
v_add_u32 v3, 49152, v3
s_waitcnt lgkmcnt(0)
s_barrier
ds_read_b128 v[72:75], v4
ds_read_b128 v[76:79], v4 offset:1024
ds_read_b128 v[80:83], v5
ds_read_b128 v[84:87], v5 offset:1024
ds_read_b128 v[88:91], v3
ds_read_b128 v[92:95], v3 offset:1024
v_pk_add_f32 v[64:65], v[64:65], v[32:33]
v_pk_add_f32 v[66:67], v[66:67], v[34:35]
v_pk_add_f32 v[68:69], v[68:69], v[36:37]
v_pk_add_f32 v[70:71], v[70:71], v[38:39]
s_waitcnt lgkmcnt(0)
s_barrier
v_pk_add_f32 v[72:73], v[72:73], v[80:81]
v_pk_add_f32 v[74:75], v[74:75], v[82:83]
v_pk_add_f32 v[76:77], v[76:77], v[84:85]
v_pk_add_f32 v[78:79], v[78:79], v[86:87]
v_pk_add_f32 v[64:65], v[64:65], v[88:89]
v_pk_add_f32 v[66:67], v[66:67], v[90:91]
v_pk_add_f32 v[68:69], v[68:69], v[92:93]
v_pk_add_f32 v[70:71], v[70:71], v[94:95]
v_pk_add_f32 v[64:65], v[64:65], v[72:73]
v_pk_add_f32 v[66:67], v[66:67], v[74:75]
v_pk_add_f32 v[68:69], v[68:69], v[76:77]
v_pk_add_f32 v[70:71], v[70:71], v[78:79]
v_cvt_pk_bf16_f32 v160, v64, v65
v_cvt_pk_bf16_f32 v161, v66, v67
v_cvt_pk_bf16_f32 v162, v68, v69
v_cvt_pk_bf16_f32 v163, v70, v71
s_lshl_b32 s58, s7, 2
s_add_u32 s58, s58, s9
s_lshl_b32 s56, s10, 5
s_add_u32 s56, s56, s58
s_lshl_b32 s56, s56, 10
s_add_u32 s56, s56, 2097152
buffer_store_dwordx4 v[160:163], v2, s[44:47], s56 offen sc1
v_pk_add_f32 v[50:51], v[64:65], v[66:67]
v_pk_add_f32 v[52:53], v[68:69], v[70:71]
v_pk_add_f32 v[50:51], v[50:51], v[52:53]
v_add_f32 v48, v50, v51
v_mov_b32 v4, v48
s_nop 1
v_permlane32_swap_b32 v48, v4
v_add_f32 v48, v48, v4
v_mul_f32 v48, 0.0625, v48
v_pk_add_f32 v[64:65], v[64:65], v[48:49] op_sel_hi:[1,0] neg_lo:[0,1] neg_hi:[0,1]
v_pk_add_f32 v[66:67], v[66:67], v[48:49] op_sel_hi:[1,0] neg_lo:[0,1] neg_hi:[0,1]
v_pk_add_f32 v[68:69], v[68:69], v[48:49] op_sel_hi:[1,0] neg_lo:[0,1] neg_hi:[0,1]
v_pk_add_f32 v[70:71], v[70:71], v[48:49] op_sel_hi:[1,0] neg_lo:[0,1] neg_hi:[0,1]
v_pk_mul_f32 v[50:51], v[64:65], v[64:65]
v_pk_mul_f32 v[52:53], v[66:67], v[66:67]
v_pk_fma_f32 v[50:51], v[68:69], v[68:69], v[50:51]
v_pk_fma_f32 v[52:53], v[70:71], v[70:71], v[52:53]
v_pk_add_f32 v[50:51], v[50:51], v[52:53]
v_add_f32 v49, v50, v51
v_mov_b32 v4, v49
s_nop 1
v_permlane32_swap_b32 v49, v4
v_add_f32 v49, v49, v4
s_lshl_b32 s56, s58, 8
s_lshl_b32 s57, s10, 13
s_add_u32 s56, s56, s57
s_add_u32 s56, s56, 12582912
v_lshlrev_b32 v4, 3, v1
s_mov_b32 exec_hi, 0
buffer_store_dwordx2 v[48:49], v4, s[44:47], s56 offen sc1
s_mov_b64 exec, -1
s_and_b32 s57, s10, 3
s_lshl_b32 s57, s57, 5
s_add_u32 s57, s57, s58
s_add_u32 s56, s11, 16
s_lshl_b32 s56, s56, 10
s_lshl_b32 s57, s57, 3
s_add_u32 s56, s56, s57
s_add_u32 s56, s56, 14155776
v_mov_b32 v4, s96
v_mov_b32 v5, s97
v_mov_b32 v3, 0
s_waitcnt vmcnt(0)
s_mov_b64 exec, 1
s_cmp_eq_u32 s98, 0
s_cbranch_scc1 L_pubslow_8
buffer_store_dwordx2 v[4:5], v3, s[44:47], s56 offen
s_branch L_pubdone_9
L_pubslow_8:
buffer_store_dwordx2 v[4:5], v3, s[44:47], s56 offen sc1
L_pubdone_9:
s_mov_b64 exec, -1
v_bfe_u32 v4, v1, 4, 1
v_lshlrev_b32 v3, 12, v4
v_and_b32 v5, 3, v1
v_lshl_add_u32 v3, v5, 3, v3
v_bfe_u32 v5, v1, 2, 2
v_lshl_add_u32 v8, v5, 7, v3
v_lshl_add_u32 v14, v5, 6, v3
v_lshl_add_u32 v17, v5, 5, v3
v_lshrrev_b32 v5, 1, v5
v_lshl_add_u32 v5, v4, 1, v5
s_lshl_b32 s56, s5, 1
v_xor_b32 v5, s56, v5
v_lshl_add_u32 v8, v5, 5, v8
v_lshrrev_b32 v5, 5, v1
v_lshl_add_u32 v8, v5, 9, v8
v_lshl_add_u32 v14, v5, 8, v14
v_xor_b32 v5, v5, v4
v_lshl_add_u32 v17, v5, 7, v17
v_xor_b32 v4, s5, v4
v_lshl_add_u32 v14, v4, 5, v14
s_mul_i32 s56, s5, 528
v_xor_b32 v17, s56, v17
v_xor_b32 v9, 32, v8
v_add_u32 v10, 65536, v8
v_add_u32 v11, 65536, v9
v_add_u32 v12, 131072, v8
v_add_u32 v13, 131072, v9
v_add_u32 v15, 65536, v14
v_add_u32 v16, 131072, v14
v_add_u32 v18, 65536, v17
v_add_u32 v19, 131072, v17
s_lshl_b32 s56, s4, 11
v_add_u32 v20, s56, v2
s_lshl_b32 s57, s5, 10
v_add_u32 v22, s57, v20
v_add_u32 v64, 65536, v20
v_add_u32 v65, 131072, v20
v_add_u32 v66, 65536, v22
v_add_u32 v67, 131072, v22
s_add_u32 s56, s11, 16
s_lshl_b32 s56, s56, 10
s_lshl_b32 s57, s4, 8
s_add_u32 s56, s56, s57
s_add_u32 s56, s56, 14155776
v_and_b32 v4, 31, v1
v_lshlrev_b32 v4, 3, v4
s_mov_b32 s57, 0
L_poll_10:
buffer_load_dwordx2 v[6:7], v4, s[44:47], s56 offen sc1
s_add_u32 s57, s57, 1
s_cmp_gt_u32 s57, 0x40000
s_cbranch_scc1 L_polld_11
s_waitcnt vmcnt(0)
v_cmp_ne_u64 vcc, s[96:97], v[6:7]
s_cbranch_vccnz L_poll_10
L_polld_11:
s_waitcnt vmcnt(0)
s_cmp_lg_u32 s98, 0
s_cbranch_scc1 L_noacq_12
buffer_inv sc1
s_waitcnt vmcnt(0)
L_noacq_12:
s_lshl_b32 s56, s4, 11
s_lshl_b32 s57, s5, 10
s_add_u32 s56, s56, s57
s_lshl_b32 s58, s13, 15
s_add_u32 s58, s58, s57
s_add_u32 s58, s58, 2097152
s_add_u32 m0, s56, 0
s_add_u32 s59, s58, 0
buffer_load_dwordx4 v2, s[44:47], s59 offen sc1 lds
s_add_u32 m0, s56, 8192
s_add_u32 s59, s58, 2048
buffer_load_dwordx4 v2, s[44:47], s59 offen sc1 lds
s_add_u32 m0, s56, 16384
s_add_u32 s59, s58, 4096
buffer_load_dwordx4 v2, s[44:47], s59 offen sc1 lds
s_add_u32 m0, s56, 24576
s_add_u32 s59, s58, 6144
buffer_load_dwordx4 v2, s[44:47], s59 offen sc1 lds
s_barrier
s_lshl_b32 s59, s2, 3
s_add_u32 s59, s59, s3
v_lshlrev_b32 v4, 7, v1
s_mov_b32 s76, s28
s_mov_b32 s77, s29
s_mov_b32 s78, 1835008
s_mov_b32 s79, 0x00020000
s_mul_i32 s56, s59, 896
s_bfm_b64 exec, 7, 0
buffer_load_dword v6, v4, s[76:79], s56 offen
s_mov_b64 exec, -1
s_waitcnt lgkmcnt(0)
s_waitcnt vmcnt(3)
s_barrier
ds_read_b128 v[40:43], v20 offset:0
ds_read_b128 v[44:47], v20 offset:1024
ds_read_b128 v[48:51], v22 offset:0
ds_read_b64_tr_b16 v[24:25], v12 offset:8192
ds_read_b64_tr_b16 v[26:27], v12 offset:9216
ds_read_b64_tr_b16 v[28:29], v13 offset:8192
ds_read_b64_tr_b16 v[30:31], v13 offset:9216
ds_read_b64_tr_b16 v[32:33], v16 offset:0
ds_read_b64_tr_b16 v[34:35], v16 offset:512
ds_read_b64_tr_b16 v[36:37], v18 offset:57344
ds_read_b64_tr_b16 v[38:39], v18 offset:57600
s_waitcnt lgkmcnt(6)
v_mfma_f32_32x32x16_bf16 v[68:83], v[24:27], v[40:43], 0
ds_read_b64_tr_b16 v[24:25], v12 offset:10240
ds_read_b64_tr_b16 v[26:27], v12 offset:11264
s_waitcnt lgkmcnt(6)
v_mfma_f32_32x32x16_bf16 v[84:99], v[28:31], v[40:43], 0
ds_read_b64_tr_b16 v[28:29], v13 offset:10240
ds_read_b64_tr_b16 v[30:31], v13 offset:11264
s_waitcnt lgkmcnt(6)
v_mfma_f32_32x32x16_bf16 v[100:115], v[32:35], v[40:43], 0
ds_read_b64_tr_b16 v[32:33], v16 offset:1024
ds_read_b64_tr_b16 v[34:35], v16 offset:1536
s_waitcnt lgkmcnt(6)
v_mfma_f32_32x32x16_bf16 v[116:131], v[36:39], v[48:51], 0
ds_read_b128 v[52:55], v20 offset:8192
ds_read_b128 v[56:59], v20 offset:9216
ds_read_b128 v[60:63], v22 offset:8192
ds_read_b64_tr_b16 v[36:37], v10 offset:49152
ds_read_b64_tr_b16 v[38:39], v10 offset:50176
s_waitcnt lgkmcnt(9)
v_mfma_f32_32x32x16_bf16 v[68:83], v[24:27], v[44:47], v[68:83]
ds_read_b64_tr_b16 v[24:25], v11 offset:49152
ds_read_b64_tr_b16 v[26:27], v11 offset:50176
s_waitcnt lgkmcnt(9)
v_mfma_f32_32x32x16_bf16 v[84:99], v[28:31], v[44:47], v[84:99]
ds_read_b64_tr_b16 v[28:29], v16 offset:2048
ds_read_b64_tr_b16 v[30:31], v16 offset:2560
s_waitcnt lgkmcnt(9)
v_mfma_f32_32x32x16_bf16 v[100:115], v[32:35], v[44:47], v[100:115]
ds_read_b64_tr_b16 v[32:33], v18 offset:58368
ds_read_b64_tr_b16 v[34:35], v18 offset:58624
s_waitcnt lgkmcnt(6)
v_mfma_f32_32x32x16_bf16 v[68:83], v[36:39], v[52:55], v[68:83]
ds_read_b64_tr_b16 v[36:37], v10 offset:51200
ds_read_b64_tr_b16 v[38:39], v10 offset:52224
s_waitcnt lgkmcnt(6)
v_mfma_f32_32x32x16_bf16 v[84:99], v[24:27], v[52:55], v[84:99]
ds_read_b64_tr_b16 v[24:25], v11 offset:51200
ds_read_b64_tr_b16 v[26:27], v11 offset:52224
s_waitcnt lgkmcnt(6)
v_mfma_f32_32x32x16_bf16 v[100:115], v[28:31], v[52:55], v[100:115]
ds_read_b64_tr_b16 v[28:29], v16 offset:3072
ds_read_b64_tr_b16 v[30:31], v16 offset:3584
s_waitcnt lgkmcnt(6)
v_mfma_f32_32x32x16_bf16 v[116:131], v[32:35], v[60:63], v[116:131]
s_waitcnt lgkmcnt(0)
s_waitcnt vmcnt(1)
s_barrier
ds_read_b128 v[40:43], v20 offset:16384
ds_read_b128 v[44:47], v20 offset:17408
ds_read_b128 v[48:51], v22 offset:16384
ds_read_b64_tr_b16 v[32:33], v10 offset:40960
ds_read_b64_tr_b16 v[34:35], v10 offset:41984
v_mfma_f32_32x32x16_bf16 v[68:83], v[36:39], v[56:59], v[68:83]
ds_read_b64_tr_b16 v[36:37], v11 offset:40960
ds_read_b64_tr_b16 v[38:39], v11 offset:41984
v_mfma_f32_32x32x16_bf16 v[84:99], v[24:27], v[56:59], v[84:99]
ds_read_b64_tr_b16 v[24:25], v15 offset:32768
ds_read_b64_tr_b16 v[26:27], v15 offset:33280
v_mfma_f32_32x32x16_bf16 v[100:115], v[28:31], v[56:59], v[100:115]
ds_read_b64_tr_b16 v[28:29], v18 offset:59392
ds_read_b64_tr_b16 v[30:31], v18 offset:59648
s_waitcnt lgkmcnt(6)
v_mfma_f32_32x32x16_bf16 v[68:83], v[32:35], v[40:43], v[68:83]
ds_read_b64_tr_b16 v[32:33], v10 offset:43008
ds_read_b64_tr_b16 v[34:35], v10 offset:44032
s_waitcnt lgkmcnt(6)
v_mfma_f32_32x32x16_bf16 v[84:99], v[36:39], v[40:43], v[84:99]
ds_read_b64_tr_b16 v[36:37], v11 offset:43008
ds_read_b64_tr_b16 v[38:39], v11 offset:44032
s_waitcnt lgkmcnt(6)
v_mfma_f32_32x32x16_bf16 v[100:115], v[24:27], v[40:43], v[100:115]
ds_read_b64_tr_b16 v[24:25], v15 offset:33792
ds_read_b64_tr_b16 v[26:27], v15 offset:34304
s_waitcnt lgkmcnt(6)
v_mfma_f32_32x32x16_bf16 v[116:131], v[28:31], v[48:51], v[116:131]
ds_read_b128 v[52:55], v20 offset:24576
ds_read_b128 v[56:59], v20 offset:25600
ds_read_b128 v[60:63], v22 offset:24576
ds_read_b64_tr_b16 v[28:29], v10 offset:24576
ds_read_b64_tr_b16 v[30:31], v10 offset:25600
s_waitcnt lgkmcnt(9)
v_mfma_f32_32x32x16_bf16 v[68:83], v[32:35], v[44:47], v[68:83]
ds_read_b64_tr_b16 v[32:33], v11 offset:24576
ds_read_b64_tr_b16 v[34:35], v11 offset:25600
s_waitcnt lgkmcnt(9)
v_mfma_f32_32x32x16_bf16 v[84:99], v[36:39], v[44:47], v[84:99]
ds_read_b64_tr_b16 v[36:37], v15 offset:34816
ds_read_b64_tr_b16 v[38:39], v15 offset:35328
s_waitcnt lgkmcnt(9)
v_mfma_f32_32x32x16_bf16 v[100:115], v[24:27], v[44:47], v[100:115]
ds_read_b64_tr_b16 v[24:25], v18 offset:60416
ds_read_b64_tr_b16 v[26:27], v18 offset:60672
s_waitcnt lgkmcnt(6)
v_mfma_f32_32x32x16_bf16 v[68:83], v[28:31], v[52:55], v[68:83]
ds_read_b64_tr_b16 v[28:29], v10 offset:26624
ds_read_b64_tr_b16 v[30:31], v10 offset:27648
s_waitcnt lgkmcnt(6)
v_mfma_f32_32x32x16_bf16 v[84:99], v[32:35], v[52:55], v[84:99]
ds_read_b64_tr_b16 v[32:33], v11 offset:26624
ds_read_b64_tr_b16 v[34:35], v11 offset:27648
s_waitcnt lgkmcnt(6)
v_mfma_f32_32x32x16_bf16 v[100:115], v[36:39], v[52:55], v[100:115]
ds_read_b64_tr_b16 v[36:37], v15 offset:35840
ds_read_b64_tr_b16 v[38:39], v15 offset:36352
s_waitcnt lgkmcnt(6)
v_mfma_f32_32x32x16_bf16 v[116:131], v[24:27], v[60:63], v[116:131]
s_waitcnt lgkmcnt(0)
s_barrier
ds_read_b128 v[40:43], v20 offset:32768
ds_read_b128 v[44:47], v20 offset:33792
ds_read_b128 v[48:51], v22 offset:32768
ds_read_b64_tr_b16 v[24:25], v10 offset:16384
ds_read_b64_tr_b16 v[26:27], v10 offset:17408
v_mfma_f32_32x32x16_bf16 v[68:83], v[28:31], v[56:59], v[68:83]
ds_read_b64_tr_b16 v[28:29], v11 offset:16384
ds_read_b64_tr_b16 v[30:31], v11 offset:17408
v_mfma_f32_32x32x16_bf16 v[84:99], v[32:35], v[56:59], v[84:99]
ds_read_b64_tr_b16 v[32:33], v15 offset:8192
ds_read_b64_tr_b16 v[34:35], v15 offset:8704
v_mfma_f32_32x32x16_bf16 v[100:115], v[36:39], v[56:59], v[100:115]
ds_read_b64_tr_b16 v[36:37], v18 offset:0
ds_read_b64_tr_b16 v[38:39], v18 offset:256
s_waitcnt lgkmcnt(6)
v_mfma_f32_32x32x16_bf16 v[68:83], v[24:27], v[40:43], v[68:83]
ds_read_b64_tr_b16 v[24:25], v10 offset:18432
ds_read_b64_tr_b16 v[26:27], v10 offset:19456
s_waitcnt lgkmcnt(6)
v_mfma_f32_32x32x16_bf16 v[84:99], v[28:31], v[40:43], v[84:99]
ds_read_b64_tr_b16 v[28:29], v11 offset:18432
ds_read_b64_tr_b16 v[30:31], v11 offset:19456
s_waitcnt lgkmcnt(6)
v_mfma_f32_32x32x16_bf16 v[100:115], v[32:35], v[40:43], v[100:115]
ds_read_b64_tr_b16 v[32:33], v15 offset:9216
ds_read_b64_tr_b16 v[34:35], v15 offset:9728
s_waitcnt lgkmcnt(6)
v_mfma_f32_32x32x16_bf16 v[116:131], v[36:39], v[48:51], v[116:131]
ds_read_b128 v[52:55], v20 offset:40960
ds_read_b128 v[56:59], v20 offset:41984
ds_read_b128 v[60:63], v22 offset:40960
ds_read_b64_tr_b16 v[36:37], v12 offset:16384
ds_read_b64_tr_b16 v[38:39], v12 offset:17408
s_waitcnt lgkmcnt(9)
v_mfma_f32_32x32x16_bf16 v[68:83], v[24:27], v[44:47], v[68:83]
ds_read_b64_tr_b16 v[24:25], v13 offset:16384
ds_read_b64_tr_b16 v[26:27], v13 offset:17408
s_waitcnt lgkmcnt(9)
v_mfma_f32_32x32x16_bf16 v[84:99], v[28:31], v[44:47], v[84:99]
ds_read_b64_tr_b16 v[28:29], v15 offset:10240
ds_read_b64_tr_b16 v[30:31], v15 offset:10752
s_waitcnt lgkmcnt(9)
v_mfma_f32_32x32x16_bf16 v[100:115], v[32:35], v[44:47], v[100:115]
ds_read_b64_tr_b16 v[32:33], v18 offset:1024
ds_read_b64_tr_b16 v[34:35], v18 offset:1280
s_waitcnt lgkmcnt(6)
v_mfma_f32_32x32x16_bf16 v[68:83], v[36:39], v[52:55], v[68:83]
ds_read_b64_tr_b16 v[36:37], v12 offset:18432
ds_read_b64_tr_b16 v[38:39], v12 offset:19456
s_waitcnt lgkmcnt(6)
v_mfma_f32_32x32x16_bf16 v[84:99], v[24:27], v[52:55], v[84:99]
ds_read_b64_tr_b16 v[24:25], v13 offset:18432
ds_read_b64_tr_b16 v[26:27], v13 offset:19456
s_waitcnt lgkmcnt(6)
v_mfma_f32_32x32x16_bf16 v[100:115], v[28:31], v[52:55], v[100:115]
ds_read_b64_tr_b16 v[28:29], v15 offset:11264
ds_read_b64_tr_b16 v[30:31], v15 offset:11776
s_waitcnt lgkmcnt(6)
v_mfma_f32_32x32x16_bf16 v[116:131], v[32:35], v[60:63], v[116:131]
s_waitcnt lgkmcnt(0)
s_barrier
ds_read_b128 v[40:43], v20 offset:0
ds_read_b128 v[44:47], v20 offset:1024
ds_read_b128 v[48:51], v22 offset:0
ds_read_b64_tr_b16 v[32:33], v8 offset:57344
ds_read_b64_tr_b16 v[34:35], v8 offset:58368
v_mfma_f32_32x32x16_bf16 v[68:83], v[36:39], v[56:59], v[68:83]
ds_read_b64_tr_b16 v[36:37], v9 offset:57344
ds_read_b64_tr_b16 v[38:39], v9 offset:58368
v_mfma_f32_32x32x16_bf16 v[84:99], v[24:27], v[56:59], v[84:99]
ds_read_b64_tr_b16 v[24:25], v14 offset:49152
ds_read_b64_tr_b16 v[26:27], v14 offset:49664
v_mfma_f32_32x32x16_bf16 v[100:115], v[28:31], v[56:59], v[100:115]
ds_read_b64_tr_b16 v[28:29], v18 offset:2048
ds_read_b64_tr_b16 v[30:31], v18 offset:2304
s_waitcnt lgkmcnt(6)
v_mfma_f32_32x32x16_bf16 v[68:83], v[32:35], v[40:43], v[68:83]
ds_read_b64_tr_b16 v[32:33], v8 offset:59392
ds_read_b64_tr_b16 v[34:35], v8 offset:60416
s_waitcnt lgkmcnt(6)
v_mfma_f32_32x32x16_bf16 v[84:99], v[36:39], v[40:43], v[84:99]
ds_read_b64_tr_b16 v[36:37], v9 offset:59392
ds_read_b64_tr_b16 v[38:39], v9 offset:60416
s_waitcnt lgkmcnt(6)
v_mfma_f32_32x32x16_bf16 v[100:115], v[24:27], v[40:43], v[100:115]
ds_read_b64_tr_b16 v[24:25], v14 offset:50176
ds_read_b64_tr_b16 v[26:27], v14 offset:50688
s_waitcnt lgkmcnt(6)
v_mfma_f32_32x32x16_bf16 v[116:131], v[28:31], v[48:51], v[116:131]
ds_read_b128 v[52:55], v20 offset:8192
ds_read_b128 v[56:59], v20 offset:9216
ds_read_b128 v[60:63], v22 offset:8192
ds_read_b64_tr_b16 v[28:29], v10 offset:49152
ds_read_b64_tr_b16 v[30:31], v10 offset:50176
s_waitcnt lgkmcnt(9)
v_mfma_f32_32x32x16_bf16 v[68:83], v[32:35], v[44:47], v[68:83]
ds_read_b64_tr_b16 v[32:33], v11 offset:49152
ds_read_b64_tr_b16 v[34:35], v11 offset:50176
s_waitcnt lgkmcnt(9)
v_mfma_f32_32x32x16_bf16 v[84:99], v[36:39], v[44:47], v[84:99]
ds_read_b64_tr_b16 v[36:37], v14 offset:51200
ds_read_b64_tr_b16 v[38:39], v14 offset:51712
s_waitcnt lgkmcnt(9)
v_mfma_f32_32x32x16_bf16 v[100:115], v[24:27], v[44:47], v[100:115]
ds_read_b64_tr_b16 v[24:25], v18 offset:3072
ds_read_b64_tr_b16 v[26:27], v18 offset:3328
s_waitcnt lgkmcnt(6)
v_mfma_f32_32x32x16_bf16 v[68:83], v[28:31], v[52:55], v[68:83]
ds_read_b64_tr_b16 v[28:29], v10 offset:51200
ds_read_b64_tr_b16 v[30:31], v10 offset:52224
s_waitcnt lgkmcnt(6)
v_mfma_f32_32x32x16_bf16 v[84:99], v[32:35], v[52:55], v[84:99]
ds_read_b64_tr_b16 v[32:33], v11 offset:51200
ds_read_b64_tr_b16 v[34:35], v11 offset:52224
s_waitcnt lgkmcnt(6)
v_mfma_f32_32x32x16_bf16 v[100:115], v[36:39], v[52:55], v[100:115]
ds_read_b64_tr_b16 v[36:37], v14 offset:52224
ds_read_b64_tr_b16 v[38:39], v14 offset:52736
s_waitcnt lgkmcnt(6)
v_mfma_f32_32x32x16_bf16 v[116:131], v[24:27], v[60:63], v[116:131]
s_waitcnt lgkmcnt(0)
s_barrier
ds_read_b128 v[40:43], v20 offset:16384
ds_read_b128 v[44:47], v20 offset:17408
ds_read_b128 v[48:51], v22 offset:16384
ds_read_b64_tr_b16 v[24:25], v12 offset:8192
ds_read_b64_tr_b16 v[26:27], v12 offset:9216
v_mfma_f32_32x32x16_bf16 v[68:83], v[28:31], v[56:59], v[68:83]
ds_read_b64_tr_b16 v[28:29], v13 offset:8192
ds_read_b64_tr_b16 v[30:31], v13 offset:9216
v_mfma_f32_32x32x16_bf16 v[84:99], v[32:35], v[56:59], v[84:99]
ds_read_b64_tr_b16 v[32:33], v16 offset:0
ds_read_b64_tr_b16 v[34:35], v16 offset:512
v_mfma_f32_32x32x16_bf16 v[100:115], v[36:39], v[56:59], v[100:115]
ds_read_b64_tr_b16 v[36:37], v18 offset:57344
ds_read_b64_tr_b16 v[38:39], v18 offset:57600
s_waitcnt lgkmcnt(6)
v_mfma_f32_32x32x16_bf16 v[68:83], v[24:27], v[40:43], v[68:83]
ds_read_b64_tr_b16 v[24:25], v12 offset:10240
ds_read_b64_tr_b16 v[26:27], v12 offset:11264
s_waitcnt lgkmcnt(6)
v_mfma_f32_32x32x16_bf16 v[84:99], v[28:31], v[40:43], v[84:99]
ds_read_b64_tr_b16 v[28:29], v13 offset:10240
ds_read_b64_tr_b16 v[30:31], v13 offset:11264
s_waitcnt lgkmcnt(6)
v_mfma_f32_32x32x16_bf16 v[100:115], v[32:35], v[40:43], v[100:115]
ds_read_b64_tr_b16 v[32:33], v16 offset:1024
ds_read_b64_tr_b16 v[34:35], v16 offset:1536
s_waitcnt lgkmcnt(6)
v_mfma_f32_32x32x16_bf16 v[116:131], v[36:39], v[48:51], v[116:131]
ds_read_b128 v[52:55], v20 offset:24576
ds_read_b128 v[56:59], v20 offset:25600
ds_read_b128 v[60:63], v22 offset:24576
ds_read_b64_tr_b16 v[36:37], v10 offset:24576
ds_read_b64_tr_b16 v[38:39], v10 offset:25600
s_waitcnt lgkmcnt(9)
v_mfma_f32_32x32x16_bf16 v[68:83], v[24:27], v[44:47], v[68:83]
ds_read_b64_tr_b16 v[24:25], v11 offset:24576
ds_read_b64_tr_b16 v[26:27], v11 offset:25600
s_waitcnt lgkmcnt(9)
v_mfma_f32_32x32x16_bf16 v[84:99], v[28:31], v[44:47], v[84:99]
ds_read_b64_tr_b16 v[28:29], v16 offset:2048
ds_read_b64_tr_b16 v[30:31], v16 offset:2560
s_waitcnt lgkmcnt(9)
v_mfma_f32_32x32x16_bf16 v[100:115], v[32:35], v[44:47], v[100:115]
ds_read_b64_tr_b16 v[32:33], v18 offset:58368
ds_read_b64_tr_b16 v[34:35], v18 offset:58624
s_waitcnt lgkmcnt(6)
v_mfma_f32_32x32x16_bf16 v[68:83], v[36:39], v[52:55], v[68:83]
ds_read_b64_tr_b16 v[36:37], v10 offset:26624
ds_read_b64_tr_b16 v[38:39], v10 offset:27648
s_waitcnt lgkmcnt(6)
v_mfma_f32_32x32x16_bf16 v[84:99], v[24:27], v[52:55], v[84:99]
ds_read_b64_tr_b16 v[24:25], v11 offset:26624
ds_read_b64_tr_b16 v[26:27], v11 offset:27648
s_waitcnt lgkmcnt(6)
v_mfma_f32_32x32x16_bf16 v[100:115], v[28:31], v[52:55], v[100:115]
ds_read_b64_tr_b16 v[28:29], v16 offset:3072
ds_read_b64_tr_b16 v[30:31], v16 offset:3584
s_waitcnt lgkmcnt(6)
v_mfma_f32_32x32x16_bf16 v[116:131], v[32:35], v[60:63], v[116:131]
s_waitcnt lgkmcnt(0)
s_barrier
ds_read_b128 v[40:43], v20 offset:32768
ds_read_b128 v[44:47], v20 offset:33792
ds_read_b128 v[48:51], v22 offset:32768
ds_read_b64_tr_b16 v[32:33], v10 offset:40960
ds_read_b64_tr_b16 v[34:35], v10 offset:41984
v_mfma_f32_32x32x16_bf16 v[68:83], v[36:39], v[56:59], v[68:83]
ds_read_b64_tr_b16 v[36:37], v11 offset:40960
ds_read_b64_tr_b16 v[38:39], v11 offset:41984
v_mfma_f32_32x32x16_bf16 v[84:99], v[24:27], v[56:59], v[84:99]
ds_read_b64_tr_b16 v[24:25], v16 offset:16384
ds_read_b64_tr_b16 v[26:27], v16 offset:16896
v_mfma_f32_32x32x16_bf16 v[100:115], v[28:31], v[56:59], v[100:115]
ds_read_b64_tr_b16 v[28:29], v18 offset:59392
ds_read_b64_tr_b16 v[30:31], v18 offset:59648
s_waitcnt lgkmcnt(6)
v_mfma_f32_32x32x16_bf16 v[68:83], v[32:35], v[40:43], v[68:83]
ds_read_b64_tr_b16 v[32:33], v10 offset:43008
ds_read_b64_tr_b16 v[34:35], v10 offset:44032
s_waitcnt lgkmcnt(6)
v_mfma_f32_32x32x16_bf16 v[84:99], v[36:39], v[40:43], v[84:99]
ds_read_b64_tr_b16 v[36:37], v11 offset:43008
ds_read_b64_tr_b16 v[38:39], v11 offset:44032
s_waitcnt lgkmcnt(6)
v_mfma_f32_32x32x16_bf16 v[100:115], v[24:27], v[40:43], v[100:115]
ds_read_b64_tr_b16 v[24:25], v16 offset:17408
ds_read_b64_tr_b16 v[26:27], v16 offset:17920
s_waitcnt lgkmcnt(6)
v_mfma_f32_32x32x16_bf16 v[116:131], v[28:31], v[48:51], v[116:131]
ds_read_b128 v[52:55], v20 offset:40960
ds_read_b128 v[56:59], v20 offset:41984
ds_read_b128 v[60:63], v22 offset:40960
ds_read_b64_tr_b16 v[28:29], v10 offset:32768
ds_read_b64_tr_b16 v[30:31], v10 offset:33792
s_waitcnt lgkmcnt(9)
v_mfma_f32_32x32x16_bf16 v[68:83], v[32:35], v[44:47], v[68:83]
ds_read_b64_tr_b16 v[32:33], v11 offset:32768
ds_read_b64_tr_b16 v[34:35], v11 offset:33792
s_waitcnt lgkmcnt(9)
v_mfma_f32_32x32x16_bf16 v[84:99], v[36:39], v[44:47], v[84:99]
ds_read_b64_tr_b16 v[36:37], v16 offset:18432
ds_read_b64_tr_b16 v[38:39], v16 offset:18944
s_waitcnt lgkmcnt(9)
v_mfma_f32_32x32x16_bf16 v[100:115], v[24:27], v[44:47], v[100:115]
ds_read_b64_tr_b16 v[24:25], v18 offset:60416
ds_read_b64_tr_b16 v[26:27], v18 offset:60672
s_waitcnt lgkmcnt(6)
v_mfma_f32_32x32x16_bf16 v[68:83], v[28:31], v[52:55], v[68:83]
ds_read_b64_tr_b16 v[28:29], v10 offset:34816
ds_read_b64_tr_b16 v[30:31], v10 offset:35840
s_waitcnt lgkmcnt(6)
v_mfma_f32_32x32x16_bf16 v[84:99], v[32:35], v[52:55], v[84:99]
ds_read_b64_tr_b16 v[32:33], v11 offset:34816
ds_read_b64_tr_b16 v[34:35], v11 offset:35840
s_waitcnt lgkmcnt(6)
v_mfma_f32_32x32x16_bf16 v[100:115], v[36:39], v[52:55], v[100:115]
ds_read_b64_tr_b16 v[36:37], v16 offset:19456
ds_read_b64_tr_b16 v[38:39], v16 offset:19968
s_waitcnt lgkmcnt(6)
v_mfma_f32_32x32x16_bf16 v[116:131], v[24:27], v[60:63], v[116:131]
s_waitcnt lgkmcnt(0)
s_barrier
ds_read_b128 v[40:43], v20 offset:0
ds_read_b128 v[44:47], v20 offset:1024
ds_read_b128 v[48:51], v22 offset:0
ds_read_b64_tr_b16 v[24:25], v10 offset:16384
ds_read_b64_tr_b16 v[26:27], v10 offset:17408
v_mfma_f32_32x32x16_bf16 v[68:83], v[28:31], v[56:59], v[68:83]
ds_read_b64_tr_b16 v[28:29], v11 offset:16384
ds_read_b64_tr_b16 v[30:31], v11 offset:17408
v_mfma_f32_32x32x16_bf16 v[84:99], v[32:35], v[56:59], v[84:99]
ds_read_b64_tr_b16 v[32:33], v15 offset:49152
ds_read_b64_tr_b16 v[34:35], v15 offset:49664
v_mfma_f32_32x32x16_bf16 v[100:115], v[36:39], v[56:59], v[100:115]
ds_read_b64_tr_b16 v[36:37], v18 offset:8192
ds_read_b64_tr_b16 v[38:39], v18 offset:8448
s_waitcnt lgkmcnt(6)
v_mfma_f32_32x32x16_bf16 v[68:83], v[24:27], v[40:43], v[68:83]
ds_read_b64_tr_b16 v[24:25], v10 offset:18432
ds_read_b64_tr_b16 v[26:27], v10 offset:19456
s_waitcnt lgkmcnt(6)
v_mfma_f32_32x32x16_bf16 v[84:99], v[28:31], v[40:43], v[84:99]
ds_read_b64_tr_b16 v[28:29], v11 offset:18432
ds_read_b64_tr_b16 v[30:31], v11 offset:19456
s_waitcnt lgkmcnt(6)
v_mfma_f32_32x32x16_bf16 v[100:115], v[32:35], v[40:43], v[100:115]
ds_read_b64_tr_b16 v[32:33], v15 offset:50176
ds_read_b64_tr_b16 v[34:35], v15 offset:50688
s_waitcnt lgkmcnt(6)
v_mfma_f32_32x32x16_bf16 v[116:131], v[36:39], v[48:51], v[116:131]
ds_read_b128 v[52:55], v20 offset:8192
ds_read_b128 v[56:59], v20 offset:9216
ds_read_b128 v[60:63], v22 offset:8192
ds_read_b64_tr_b16 v[36:37], v10 offset:0
ds_read_b64_tr_b16 v[38:39], v10 offset:1024
s_waitcnt lgkmcnt(9)
v_mfma_f32_32x32x16_bf16 v[68:83], v[24:27], v[44:47], v[68:83]
ds_read_b64_tr_b16 v[24:25], v11 offset:0
ds_read_b64_tr_b16 v[26:27], v11 offset:1024
s_waitcnt lgkmcnt(9)
v_mfma_f32_32x32x16_bf16 v[84:99], v[28:31], v[44:47], v[84:99]
ds_read_b64_tr_b16 v[28:29], v15 offset:51200
ds_read_b64_tr_b16 v[30:31], v15 offset:51712
s_waitcnt lgkmcnt(9)
v_mfma_f32_32x32x16_bf16 v[100:115], v[32:35], v[44:47], v[100:115]
ds_read_b64_tr_b16 v[32:33], v18 offset:9216
ds_read_b64_tr_b16 v[34:35], v18 offset:9472
s_waitcnt lgkmcnt(6)
v_mfma_f32_32x32x16_bf16 v[68:83], v[36:39], v[52:55], v[68:83]
ds_read_b64_tr_b16 v[36:37], v10 offset:2048
ds_read_b64_tr_b16 v[38:39], v10 offset:3072
s_waitcnt lgkmcnt(6)
v_mfma_f32_32x32x16_bf16 v[84:99], v[24:27], v[52:55], v[84:99]
ds_read_b64_tr_b16 v[24:25], v11 offset:2048
ds_read_b64_tr_b16 v[26:27], v11 offset:3072
s_waitcnt lgkmcnt(6)
v_mfma_f32_32x32x16_bf16 v[100:115], v[28:31], v[52:55], v[100:115]
ds_read_b64_tr_b16 v[28:29], v15 offset:52224
ds_read_b64_tr_b16 v[30:31], v15 offset:52736
s_waitcnt lgkmcnt(6)
v_mfma_f32_32x32x16_bf16 v[116:131], v[32:35], v[60:63], v[116:131]
s_waitcnt lgkmcnt(0)
s_barrier
ds_read_b128 v[40:43], v20 offset:16384
ds_read_b128 v[44:47], v20 offset:17408
ds_read_b128 v[48:51], v22 offset:16384
ds_read_b64_tr_b16 v[32:33], v10 offset:24576
ds_read_b64_tr_b16 v[34:35], v10 offset:25600
v_mfma_f32_32x32x16_bf16 v[68:83], v[36:39], v[56:59], v[68:83]
ds_read_b64_tr_b16 v[36:37], v11 offset:24576
ds_read_b64_tr_b16 v[38:39], v11 offset:25600
v_mfma_f32_32x32x16_bf16 v[84:99], v[24:27], v[56:59], v[84:99]
ds_read_b64_tr_b16 v[24:25], v16 offset:8192
ds_read_b64_tr_b16 v[26:27], v16 offset:8704
v_mfma_f32_32x32x16_bf16 v[100:115], v[28:31], v[56:59], v[100:115]
ds_read_b64_tr_b16 v[28:29], v18 offset:10240
ds_read_b64_tr_b16 v[30:31], v18 offset:10496
s_waitcnt lgkmcnt(6)
v_mfma_f32_32x32x16_bf16 v[68:83], v[32:35], v[40:43], v[68:83]
ds_read_b64_tr_b16 v[32:33], v10 offset:26624
ds_read_b64_tr_b16 v[34:35], v10 offset:27648
s_waitcnt lgkmcnt(6)
v_mfma_f32_32x32x16_bf16 v[84:99], v[36:39], v[40:43], v[84:99]
ds_read_b64_tr_b16 v[36:37], v11 offset:26624
ds_read_b64_tr_b16 v[38:39], v11 offset:27648
s_waitcnt lgkmcnt(6)
v_mfma_f32_32x32x16_bf16 v[100:115], v[24:27], v[40:43], v[100:115]
ds_read_b64_tr_b16 v[24:25], v16 offset:9216
ds_read_b64_tr_b16 v[26:27], v16 offset:9728
s_waitcnt lgkmcnt(6)
v_mfma_f32_32x32x16_bf16 v[116:131], v[28:31], v[48:51], v[116:131]
ds_read_b128 v[52:55], v20 offset:24576
ds_read_b128 v[56:59], v20 offset:25600
ds_read_b128 v[60:63], v22 offset:24576
ds_read_b64_tr_b16 v[28:29], v12 offset:0
ds_read_b64_tr_b16 v[30:31], v12 offset:1024
s_waitcnt lgkmcnt(9)
v_mfma_f32_32x32x16_bf16 v[68:83], v[32:35], v[44:47], v[68:83]
ds_read_b64_tr_b16 v[32:33], v13 offset:0
ds_read_b64_tr_b16 v[34:35], v13 offset:1024
s_waitcnt lgkmcnt(9)
v_mfma_f32_32x32x16_bf16 v[84:99], v[36:39], v[44:47], v[84:99]
ds_read_b64_tr_b16 v[36:37], v16 offset:10240
ds_read_b64_tr_b16 v[38:39], v16 offset:10752
s_waitcnt lgkmcnt(9)
v_mfma_f32_32x32x16_bf16 v[100:115], v[24:27], v[44:47], v[100:115]
ds_read_b64_tr_b16 v[24:25], v18 offset:11264
ds_read_b64_tr_b16 v[26:27], v18 offset:11520
s_waitcnt lgkmcnt(6)
v_mfma_f32_32x32x16_bf16 v[68:83], v[28:31], v[52:55], v[68:83]
ds_read_b64_tr_b16 v[28:29], v12 offset:2048
ds_read_b64_tr_b16 v[30:31], v12 offset:3072
s_waitcnt lgkmcnt(6)
v_mfma_f32_32x32x16_bf16 v[84:99], v[32:35], v[52:55], v[84:99]
ds_read_b64_tr_b16 v[32:33], v13 offset:2048
ds_read_b64_tr_b16 v[34:35], v13 offset:3072
s_waitcnt lgkmcnt(6)
v_mfma_f32_32x32x16_bf16 v[100:115], v[36:39], v[52:55], v[100:115]
ds_read_b64_tr_b16 v[36:37], v16 offset:11264
ds_read_b64_tr_b16 v[38:39], v16 offset:11776
s_waitcnt lgkmcnt(6)
v_mfma_f32_32x32x16_bf16 v[116:131], v[24:27], v[60:63], v[116:131]
s_waitcnt lgkmcnt(4)
v_mfma_f32_32x32x16_bf16 v[68:83], v[28:31], v[56:59], v[68:83]
s_waitcnt lgkmcnt(2)
v_mfma_f32_32x32x16_bf16 v[84:99], v[32:35], v[56:59], v[84:99]
s_waitcnt lgkmcnt(0)
v_mfma_f32_32x32x16_bf16 v[100:115], v[36:39], v[56:59], v[100:115]
s_waitcnt lgkmcnt(0)
s_barrier
s_xor_b32 s56, s3, 4
s_lshl_b32 s56, s56, 11
s_add_u32 s56, s56, 0
v_add_u32 v4, s56, v2
ds_write_b128 v4, v[120:123]
ds_write_b128 v4, v[128:131] offset:1024
v_and_b32 v4, 31, v1
s_lshl_b32 s56, s4, 9
s_add_u32 s56, s56, 161792
v_lshl_add_u32 v4, v4, 4, s56
ds_read_b128 v[132:135], v4
v_lshrrev_b32 v23, 5, v1
v_lshlrev_b32 v23, 4, v23
v_add_u32 v23, 155648, v23
s_mul_i32 s74, s13, 112
s_mul_i32 s75, s12, 7
s_add_u32 s74, s74, s75
s_lshl_b32 s74, s74, 10
s_add_u32 s74, s74, 4194304
s_and_b32 s75, s12, 3
s_lshl_b32 s70, s5, 1
s_add_u32 s70, s70, s75
s_add_u32 s71, s70, 1
s_mul_i32 s59, s75, 7
s_and_b32 s72, s14, 0xff
s_sub_u32 s72, s72, s59
s_add_u32 s72, s72, s5
s_lshr_b32 s73, s14, 8
s_sub_u32 s73, s73, s59
s_lshl_b32 s59, s70, 7
v_add_u32 v3, s59, v23
ds_read_b128 v[40:43], v3 offset:0
ds_read_b128 v[44:47], v3 offset:32
ds_read_b128 v[48:51], v3 offset:64
ds_read_b128 v[52:55], v3 offset:96
s_lshl_b32 s59, s71, 7
v_add_u32 v3, s59, v23
ds_read_b128 v[136:139], v3 offset:0
ds_read_b128 v[140:143], v3 offset:32
ds_read_b128 v[144:147], v3 offset:64
ds_read_b128 v[148:151], v3 offset:96
s_waitcnt lgkmcnt(4)
v_pk_fma_f32 v[68:69], v[132:133], v[40:41], v[68:69] op_sel:[0,0,0] op_sel_hi:[0,1,1]
v_pk_fma_f32 v[70:71], v[132:133], v[42:43], v[70:71] op_sel:[0,0,0] op_sel_hi:[0,1,1]
v_pk_fma_f32 v[72:73], v[132:133], v[44:45], v[72:73] op_sel:[0,0,0] op_sel_hi:[0,1,1]
v_pk_fma_f32 v[74:75], v[132:133], v[46:47], v[74:75] op_sel:[0,0,0] op_sel_hi:[0,1,1]
v_pk_fma_f32 v[76:77], v[132:133], v[48:49], v[76:77] op_sel:[0,0,0] op_sel_hi:[0,1,1]
v_pk_fma_f32 v[78:79], v[132:133], v[50:51], v[78:79] op_sel:[0,0,0] op_sel_hi:[0,1,1]
v_pk_fma_f32 v[80:81], v[132:133], v[52:53], v[80:81] op_sel:[0,0,0] op_sel_hi:[0,1,1]
v_pk_fma_f32 v[82:83], v[132:133], v[54:55], v[82:83] op_sel:[0,0,0] op_sel_hi:[0,1,1]
v_pk_mul_f32 v[56:57], v[68:69], v[68:69]
v_pk_mul_f32 v[58:59], v[70:71], v[70:71]
v_pk_mul_f32 v[60:61], v[72:73], v[72:73]
v_pk_mul_f32 v[62:63], v[74:75], v[74:75]
v_pk_fma_f32 v[56:57], v[56:57], v[134:135], v[134:135] op_sel:[0,1,0] op_sel_hi:[1,1,0]
v_pk_fma_f32 v[58:59], v[58:59], v[134:135], v[134:135] op_sel:[0,1,0] op_sel_hi:[1,1,0]
v_pk_fma_f32 v[60:61], v[60:61], v[134:135], v[134:135] op_sel:[0,1,0] op_sel_hi:[1,1,0]
v_pk_fma_f32 v[62:63], v[62:63], v[134:135], v[134:135] op_sel:[0,1,0] op_sel_hi:[1,1,0]
v_pk_mul_f32 v[56:57], v[56:57], v[68:69]
v_pk_mul_f32 v[58:59], v[58:59], v[70:71]
v_pk_mul_f32 v[60:61], v[60:61], v[72:73]
v_pk_mul_f32 v[62:63], v[62:63], v[74:75]
v_exp_f32 v56, v56
v_pk_mul_f32 v[68:69], v[68:69], v[76:77]
v_exp_f32 v57, v57
v_exp_f32 v58, v58
v_pk_mul_f32 v[70:71], v[70:71], v[78:79]
v_exp_f32 v59, v59
v_exp_f32 v60, v60
v_pk_mul_f32 v[72:73], v[72:73], v[80:81]
v_exp_f32 v61, v61
v_exp_f32 v62, v62
v_pk_mul_f32 v[74:75], v[74:75], v[82:83]
v_exp_f32 v63, v63
v_pk_fma_f32 v[56:57], v[56:57], v[132:133], v[132:133] op_sel:[0,1,1] op_sel_hi:[1,1,1]
v_pk_fma_f32 v[58:59], v[58:59], v[132:133], v[132:133] op_sel:[0,1,1] op_sel_hi:[1,1,1]
v_pk_fma_f32 v[60:61], v[60:61], v[132:133], v[132:133] op_sel:[0,1,1] op_sel_hi:[1,1,1]
v_pk_fma_f32 v[62:63], v[62:63], v[132:133], v[132:133] op_sel:[0,1,1] op_sel_hi:[1,1,1]
v_rcp_f32 v56, v56
v_rcp_f32 v57, v57
v_rcp_f32 v58, v58
v_rcp_f32 v59, v59
v_rcp_f32 v60, v60
v_rcp_f32 v61, v61
v_rcp_f32 v62, v62
v_rcp_f32 v63, v63
v_pk_mul_f32 v[68:69], v[68:69], v[56:57]
v_pk_mul_f32 v[70:71], v[70:71], v[58:59]
v_pk_mul_f32 v[72:73], v[72:73], v[60:61]
v_pk_mul_f32 v[74:75], v[74:75], v[62:63]
v_cvt_pk_bf16_f32 v76, v68, v69
v_cvt_pk_bf16_f32 v77, v70, v71
v_cvt_pk_bf16_f32 v78, v72, v73
v_cvt_pk_bf16_f32 v79, v74, v75
s_lshl_b32 s58, s70, 10
s_add_u32 s58, s58, s74
buffer_store_dwordx4 v[76:79], v2, s[44:47], s58 offen sc1
s_waitcnt lgkmcnt(0)
s_barrier
s_lshl_b32 s56, s3, 11
s_add_u32 s56, s56, 0
v_add_u32 v4, s56, v2
ds_read_b128 v[120:123], v4
ds_read_b128 v[128:131], v4 offset:1024
s_lshl_b32 s59, s72, 7
v_add_u32 v3, s59, v23
ds_read_b128 v[40:43], v3 offset:0
ds_read_b128 v[44:47], v3 offset:32
ds_read_b128 v[48:51], v3 offset:64
ds_read_b128 v[52:55], v3 offset:96
v_pk_fma_f32 v[84:85], v[132:133], v[136:137], v[84:85] op_sel:[0,0,0] op_sel_hi:[0,1,1]
v_pk_fma_f32 v[86:87], v[132:133], v[138:139], v[86:87] op_sel:[0,0,0] op_sel_hi:[0,1,1]
v_pk_fma_f32 v[88:89], v[132:133], v[140:141], v[88:89] op_sel:[0,0,0] op_sel_hi:[0,1,1]
v_pk_fma_f32 v[90:91], v[132:133], v[142:143], v[90:91] op_sel:[0,0,0] op_sel_hi:[0,1,1]
v_pk_fma_f32 v[92:93], v[132:133], v[144:145], v[92:93] op_sel:[0,0,0] op_sel_hi:[0,1,1]
v_pk_fma_f32 v[94:95], v[132:133], v[146:147], v[94:95] op_sel:[0,0,0] op_sel_hi:[0,1,1]
v_pk_fma_f32 v[96:97], v[132:133], v[148:149], v[96:97] op_sel:[0,0,0] op_sel_hi:[0,1,1]
v_pk_fma_f32 v[98:99], v[132:133], v[150:151], v[98:99] op_sel:[0,0,0] op_sel_hi:[0,1,1]
v_pk_mul_f32 v[56:57], v[84:85], v[84:85]
v_pk_mul_f32 v[58:59], v[86:87], v[86:87]
v_pk_mul_f32 v[60:61], v[88:89], v[88:89]
v_pk_mul_f32 v[62:63], v[90:91], v[90:91]
v_pk_fma_f32 v[56:57], v[56:57], v[134:135], v[134:135] op_sel:[0,1,0] op_sel_hi:[1,1,0]
v_pk_fma_f32 v[58:59], v[58:59], v[134:135], v[134:135] op_sel:[0,1,0] op_sel_hi:[1,1,0]
v_pk_fma_f32 v[60:61], v[60:61], v[134:135], v[134:135] op_sel:[0,1,0] op_sel_hi:[1,1,0]
v_pk_fma_f32 v[62:63], v[62:63], v[134:135], v[134:135] op_sel:[0,1,0] op_sel_hi:[1,1,0]
v_pk_mul_f32 v[56:57], v[56:57], v[84:85]
v_pk_mul_f32 v[58:59], v[58:59], v[86:87]
v_pk_mul_f32 v[60:61], v[60:61], v[88:89]
v_pk_mul_f32 v[62:63], v[62:63], v[90:91]
v_exp_f32 v56, v56
v_pk_mul_f32 v[84:85], v[84:85], v[92:93]
v_exp_f32 v57, v57
v_exp_f32 v58, v58
v_pk_mul_f32 v[86:87], v[86:87], v[94:95]
v_exp_f32 v59, v59
v_exp_f32 v60, v60
v_pk_mul_f32 v[88:89], v[88:89], v[96:97]
v_exp_f32 v61, v61
v_exp_f32 v62, v62
v_pk_mul_f32 v[90:91], v[90:91], v[98:99]
v_exp_f32 v63, v63
v_pk_fma_f32 v[56:57], v[56:57], v[132:133], v[132:133] op_sel:[0,1,1] op_sel_hi:[1,1,1]
v_pk_fma_f32 v[58:59], v[58:59], v[132:133], v[132:133] op_sel:[0,1,1] op_sel_hi:[1,1,1]
v_pk_fma_f32 v[60:61], v[60:61], v[132:133], v[132:133] op_sel:[0,1,1] op_sel_hi:[1,1,1]
v_pk_fma_f32 v[62:63], v[62:63], v[132:133], v[132:133] op_sel:[0,1,1] op_sel_hi:[1,1,1]
v_rcp_f32 v56, v56
v_rcp_f32 v57, v57
v_rcp_f32 v58, v58
v_rcp_f32 v59, v59
v_rcp_f32 v60, v60
v_rcp_f32 v61, v61
v_rcp_f32 v62, v62
v_rcp_f32 v63, v63
v_pk_mul_f32 v[84:85], v[84:85], v[56:57]
v_pk_mul_f32 v[86:87], v[86:87], v[58:59]
v_pk_mul_f32 v[88:89], v[88:89], v[60:61]
v_pk_mul_f32 v[90:91], v[90:91], v[62:63]
v_cvt_pk_bf16_f32 v92, v84, v85
v_cvt_pk_bf16_f32 v93, v86, v87
v_cvt_pk_bf16_f32 v94, v88, v89
v_cvt_pk_bf16_f32 v95, v90, v91
s_lshl_b32 s58, s71, 10
s_add_u32 s58, s58, s74
buffer_store_dwordx4 v[92:95], v2, s[44:47], s58 offen sc1
s_lshl_b32 s59, s73, 7
s_lshl_b32 s58, s5, 5
s_add_u32 s59, s59, s58
v_add_u32 v3, s59, v23
ds_read_b128 v[136:139], v3
ds_read_b128 v[144:147], v3 offset:64
s_waitcnt lgkmcnt(2)
v_pk_fma_f32 v[100:101], v[132:133], v[40:41], v[100:101] op_sel:[0,0,0] op_sel_hi:[0,1,1]
v_pk_fma_f32 v[102:103], v[132:133], v[42:43], v[102:103] op_sel:[0,0,0] op_sel_hi:[0,1,1]
v_pk_fma_f32 v[104:105], v[132:133], v[44:45], v[104:105] op_sel:[0,0,0] op_sel_hi:[0,1,1]
v_pk_fma_f32 v[106:107], v[132:133], v[46:47], v[106:107] op_sel:[0,0,0] op_sel_hi:[0,1,1]
v_pk_fma_f32 v[108:109], v[132:133], v[48:49], v[108:109] op_sel:[0,0,0] op_sel_hi:[0,1,1]
v_pk_fma_f32 v[110:111], v[132:133], v[50:51], v[110:111] op_sel:[0,0,0] op_sel_hi:[0,1,1]
v_pk_fma_f32 v[112:113], v[132:133], v[52:53], v[112:113] op_sel:[0,0,0] op_sel_hi:[0,1,1]
v_pk_fma_f32 v[114:115], v[132:133], v[54:55], v[114:115] op_sel:[0,0,0] op_sel_hi:[0,1,1]
v_pk_mul_f32 v[56:57], v[100:101], v[100:101]
v_pk_mul_f32 v[58:59], v[102:103], v[102:103]
v_pk_mul_f32 v[60:61], v[104:105], v[104:105]
v_pk_mul_f32 v[62:63], v[106:107], v[106:107]
v_pk_fma_f32 v[56:57], v[56:57], v[134:135], v[134:135] op_sel:[0,1,0] op_sel_hi:[1,1,0]
v_pk_fma_f32 v[58:59], v[58:59], v[134:135], v[134:135] op_sel:[0,1,0] op_sel_hi:[1,1,0]
v_pk_fma_f32 v[60:61], v[60:61], v[134:135], v[134:135] op_sel:[0,1,0] op_sel_hi:[1,1,0]
v_pk_fma_f32 v[62:63], v[62:63], v[134:135], v[134:135] op_sel:[0,1,0] op_sel_hi:[1,1,0]
v_pk_mul_f32 v[56:57], v[56:57], v[100:101]
v_pk_mul_f32 v[58:59], v[58:59], v[102:103]
v_pk_mul_f32 v[60:61], v[60:61], v[104:105]
v_pk_mul_f32 v[62:63], v[62:63], v[106:107]
v_exp_f32 v56, v56
v_pk_mul_f32 v[100:101], v[100:101], v[108:109]
v_exp_f32 v57, v57
v_exp_f32 v58, v58
v_pk_mul_f32 v[102:103], v[102:103], v[110:111]
v_exp_f32 v59, v59
v_exp_f32 v60, v60
v_pk_mul_f32 v[104:105], v[104:105], v[112:113]
v_exp_f32 v61, v61
v_exp_f32 v62, v62
v_pk_mul_f32 v[106:107], v[106:107], v[114:115]
v_exp_f32 v63, v63
v_pk_fma_f32 v[56:57], v[56:57], v[132:133], v[132:133] op_sel:[0,1,1] op_sel_hi:[1,1,1]
v_pk_fma_f32 v[58:59], v[58:59], v[132:133], v[132:133] op_sel:[0,1,1] op_sel_hi:[1,1,1]
v_pk_fma_f32 v[60:61], v[60:61], v[132:133], v[132:133] op_sel:[0,1,1] op_sel_hi:[1,1,1]
v_pk_fma_f32 v[62:63], v[62:63], v[132:133], v[132:133] op_sel:[0,1,1] op_sel_hi:[1,1,1]
v_rcp_f32 v56, v56
v_rcp_f32 v57, v57
v_rcp_f32 v58, v58
v_rcp_f32 v59, v59
v_rcp_f32 v60, v60
v_rcp_f32 v61, v61
v_rcp_f32 v62, v62
v_rcp_f32 v63, v63
v_pk_mul_f32 v[100:101], v[100:101], v[56:57]
v_pk_mul_f32 v[102:103], v[102:103], v[58:59]
v_pk_mul_f32 v[104:105], v[104:105], v[60:61]
v_pk_mul_f32 v[106:107], v[106:107], v[62:63]
v_cvt_pk_bf16_f32 v108, v100, v101
v_cvt_pk_bf16_f32 v109, v102, v103
v_cvt_pk_bf16_f32 v110, v104, v105
v_cvt_pk_bf16_f32 v111, v106, v107
s_lshl_b32 s58, s72, 10
s_add_u32 s58, s58, s74
buffer_store_dwordx4 v[108:111], v2, s[44:47], s58 offen sc1
v_pk_add_f32 v[116:117], v[116:117], v[120:121]
v_pk_add_f32 v[118:119], v[118:119], v[122:123]
v_pk_add_f32 v[124:125], v[124:125], v[128:129]
v_pk_add_f32 v[126:127], v[126:127], v[130:131]
s_waitcnt lgkmcnt(0)
v_pk_fma_f32 v[116:117], v[132:133], v[136:137], v[116:117] op_sel:[0,0,0] op_sel_hi:[0,1,1]
v_pk_fma_f32 v[118:119], v[132:133], v[138:139], v[118:119] op_sel:[0,0,0] op_sel_hi:[0,1,1]
v_pk_fma_f32 v[124:125], v[132:133], v[144:145], v[124:125] op_sel:[0,0,0] op_sel_hi:[0,1,1]
v_pk_fma_f32 v[126:127], v[132:133], v[146:147], v[126:127] op_sel:[0,0,0] op_sel_hi:[0,1,1]
v_pk_mul_f32 v[56:57], v[116:117], v[116:117]
v_pk_mul_f32 v[58:59], v[118:119], v[118:119]
v_pk_fma_f32 v[56:57], v[56:57], v[134:135], v[134:135] op_sel:[0,1,0] op_sel_hi:[1,1,0]
v_pk_fma_f32 v[58:59], v[58:59], v[134:135], v[134:135] op_sel:[0,1,0] op_sel_hi:[1,1,0]
v_pk_mul_f32 v[56:57], v[56:57], v[116:117]
v_pk_mul_f32 v[58:59], v[58:59], v[118:119]
v_exp_f32 v56, v56
v_pk_mul_f32 v[116:117], v[116:117], v[124:125]
v_exp_f32 v57, v57
v_exp_f32 v58, v58
v_pk_mul_f32 v[118:119], v[118:119], v[126:127]
v_exp_f32 v59, v59
v_pk_fma_f32 v[56:57], v[56:57], v[132:133], v[132:133] op_sel:[0,1,1] op_sel_hi:[1,1,1]
v_pk_fma_f32 v[58:59], v[58:59], v[132:133], v[132:133] op_sel:[0,1,1] op_sel_hi:[1,1,1]
v_rcp_f32 v56, v56
v_rcp_f32 v57, v57
v_rcp_f32 v58, v58
v_rcp_f32 v59, v59
v_pk_mul_f32 v[116:117], v[116:117], v[56:57]
v_pk_mul_f32 v[118:119], v[118:119], v[58:59]
v_cvt_pk_bf16_f32 v124, v116, v117
v_cvt_pk_bf16_f32 v125, v118, v119
s_lshl_b32 s58, s73, 10
s_add_u32 s58, s58, s74
s_lshl_b32 s59, s5, 3
s_add_u32 s58, s58, s59
buffer_store_dwordx2 v[124:125], v2, s[44:47], s58 offen sc1
s_lshl_b32 s57, s4, 4
s_add_u32 s57, s57, s12
s_lshl_b32 s57, s57, 1
s_add_u32 s57, s57, s5
s_add_u32 s56, s11, 32
s_lshl_b32 s56, s56, 10
s_lshl_b32 s57, s57, 3
s_add_u32 s56, s56, s57
s_add_u32 s56, s56, 14155776
v_mov_b32 v4, s96
v_mov_b32 v5, s97
v_mov_b32 v3, 0
s_waitcnt vmcnt(0)
s_mov_b64 exec, 1
s_cmp_eq_u32 s98, 0
s_cbranch_scc1 L_pubslow_14
buffer_store_dwordx2 v[4:5], v3, s[44:47], s56 offen
s_branch L_pubdone_15
L_pubslow_14:
buffer_store_dwordx2 v[4:5], v3, s[44:47], s56 offen sc1
L_pubdone_15:
s_mov_b64 exec, -1
s_waitcnt lgkmcnt(0)
s_barrier
v_bfe_u32 v4, v1, 2, 2
v_lshlrev_b32 v14, 7, v4
v_lshrrev_b32 v4, 1, v4
v_lshl_add_u32 v14, v4, 6, v14
v_bfe_u32 v4, v1, 4, 1
v_lshl_add_u32 v14, v4, 5, v14
v_and_b32 v4, 3, v1
v_lshl_add_u32 v14, v4, 3, v14
v_lshrrev_b32 v4, 5, v1
v_lshl_add_u32 v14, v4, 9, v14
s_lshl_b32 s56, s9, 12
s_lshl_b32 s57, s9, 5
v_add_u32 v14, s56, v14
v_xor_b32 v14, s57, v14
v_xor_b32 v15, 64, v14
v_add_u32 v16, 65536, v14
v_add_u32 v17, 65536, v15
v_add_u32 v18, 131072, v14
v_add_u32 v19, 131072, v15
s_add_u32 s56, s11, 32
s_lshl_b32 s56, s56, 10
s_and_b32 s57, s10, 3
s_lshl_b32 s57, s57, 2
s_add_u32 s57, s57, s9
s_lshl_b32 s57, s57, 6
s_add_u32 s56, s56, s57
s_add_u32 s56, s56, 14155776
v_and_b32 v4, 7, v1
v_lshlrev_b32 v4, 3, v4
s_mov_b32 s57, 0
L_poll_16:
buffer_load_dwordx2 v[6:7], v4, s[44:47], s56 offen sc1
s_add_u32 s57, s57, 1
s_cmp_gt_u32 s57, 0x40000
s_cbranch_scc1 L_polld_17
s_waitcnt vmcnt(0)
v_cmp_ne_u64 vcc, s[96:97], v[6:7]
s_cbranch_vccnz L_poll_16
L_polld_17:
s_waitcnt vmcnt(0)
s_cmp_lg_u32 s98, 0
s_cbranch_scc1 L_noacq_18
buffer_inv sc1
s_waitcnt vmcnt(0)
L_noacq_18:
s_mul_i32 s58, s10, 112
s_mul_i32 s57, s9, 28
s_add_u32 s58, s58, s57
s_lshl_b32 s58, s58, 10
s_add_u32 s58, s58, 4194304
buffer_load_dwordx4 v[72:75], v2, s[44:47], s58 offen offset:0 sc1
buffer_load_dwordx4 v[76:79], v2, s[44:47], s58 offen offset:1024 sc1
buffer_load_dwordx4 v[80:83], v2, s[44:47], s58 offen offset:2048 sc1
buffer_load_dwordx4 v[84:87], v2, s[44:47], s58 offen offset:3072 sc1
s_add_u32 s58, s58, 4096
buffer_load_dwordx4 v[88:91], v2, s[44:47], s58 offen offset:0 sc1
buffer_load_dwordx4 v[92:95], v2, s[44:47], s58 offen offset:1024 sc1
s_barrier
ds_read_b64_tr_b16 v[56:57], v14 offset:49152
ds_read_b64_tr_b16 v[58:59], v14 offset:50176
ds_read_b64_tr_b16 v[60:61], v15 offset:49152
ds_read_b64_tr_b16 v[62:63], v15 offset:50176
ds_read_b64_tr_b16 v[64:65], v14 offset:51200
ds_read_b64_tr_b16 v[66:67], v14 offset:52224
ds_read_b64_tr_b16 v[68:69], v15 offset:51200
ds_read_b64_tr_b16 v[70:71], v15 offset:52224
s_waitcnt vmcnt(5)
s_waitcnt lgkmcnt(6)
v_mfma_f32_32x32x16_bf16 v[24:39], v[56:59], v[72:75], 0
ds_read_b64_tr_b16 v[56:57], v16 offset:32768
ds_read_b64_tr_b16 v[58:59], v16 offset:33792
s_waitcnt lgkmcnt(6)
v_mfma_f32_32x32x16_bf16 v[40:55], v[60:63], v[72:75], 0
buffer_load_dwordx4 v[96:99], v2, s[44:47], s58 offen offset:2048 sc1
ds_read_b64_tr_b16 v[60:61], v17 offset:32768
ds_read_b64_tr_b16 v[62:63], v17 offset:33792
s_waitcnt vmcnt(5)
s_waitcnt lgkmcnt(6)
v_mfma_f32_32x32x16_bf16 v[24:39], v[64:67], v[76:79], v[24:39]
ds_read_b64_tr_b16 v[64:65], v16 offset:34816
ds_read_b64_tr_b16 v[66:67], v16 offset:35840
s_waitcnt lgkmcnt(6)
v_mfma_f32_32x32x16_bf16 v[40:55], v[68:71], v[76:79], v[40:55]
buffer_load_dwordx4 v[100:103], v2, s[44:47], s58 offen offset:3072 sc1
ds_read_b64_tr_b16 v[68:69], v17 offset:34816
ds_read_b64_tr_b16 v[70:71], v17 offset:35840
s_waitcnt vmcnt(5)
s_waitcnt lgkmcnt(6)
v_mfma_f32_32x32x16_bf16 v[24:39], v[56:59], v[80:83], v[24:39]
ds_read_b64_tr_b16 v[56:57], v16 offset:49152
ds_read_b64_tr_b16 v[58:59], v16 offset:50176
s_waitcnt lgkmcnt(6)
v_mfma_f32_32x32x16_bf16 v[40:55], v[60:63], v[80:83], v[40:55]
s_add_u32 s58, s58, 4096
buffer_load_dwordx4 v[104:107], v2, s[44:47], s58 offen offset:0 sc1
ds_read_b64_tr_b16 v[60:61], v17 offset:49152
ds_read_b64_tr_b16 v[62:63], v17 offset:50176
s_waitcnt vmcnt(5)
s_waitcnt lgkmcnt(6)
v_mfma_f32_32x32x16_bf16 v[24:39], v[64:67], v[84:87], v[24:39]
ds_read_b64_tr_b16 v[64:65], v16 offset:51200
ds_read_b64_tr_b16 v[66:67], v16 offset:52224
s_waitcnt lgkmcnt(6)
v_mfma_f32_32x32x16_bf16 v[40:55], v[68:71], v[84:87], v[40:55]
buffer_load_dwordx4 v[108:111], v2, s[44:47], s58 offen offset:1024 sc1
s_barrier
ds_read_b64_tr_b16 v[68:69], v17 offset:51200
ds_read_b64_tr_b16 v[70:71], v17 offset:52224
s_waitcnt vmcnt(5)
s_waitcnt lgkmcnt(6)
v_mfma_f32_32x32x16_bf16 v[24:39], v[56:59], v[88:91], v[24:39]
ds_read_b64_tr_b16 v[56:57], v14 offset:16384
ds_read_b64_tr_b16 v[58:59], v14 offset:17408
s_waitcnt lgkmcnt(6)
v_mfma_f32_32x32x16_bf16 v[40:55], v[60:63], v[88:91], v[40:55]
buffer_load_dwordx4 v[112:115], v2, s[44:47], s58 offen offset:2048 sc1
ds_read_b64_tr_b16 v[60:61], v15 offset:16384
ds_read_b64_tr_b16 v[62:63], v15 offset:17408
s_waitcnt vmcnt(5)
s_waitcnt lgkmcnt(6)
v_mfma_f32_32x32x16_bf16 v[24:39], v[64:67], v[92:95], v[24:39]
ds_read_b64_tr_b16 v[64:65], v14 offset:18432
ds_read_b64_tr_b16 v[66:67], v14 offset:19456
s_waitcnt lgkmcnt(6)
v_mfma_f32_32x32x16_bf16 v[40:55], v[68:71], v[92:95], v[40:55]
buffer_load_dwordx4 v[116:119], v2, s[44:47], s58 offen offset:3072 sc1
ds_read_b64_tr_b16 v[68:69], v15 offset:18432
ds_read_b64_tr_b16 v[70:71], v15 offset:19456
s_waitcnt vmcnt(5)
s_waitcnt lgkmcnt(6)
v_mfma_f32_32x32x16_bf16 v[24:39], v[56:59], v[96:99], v[24:39]
ds_read_b64_tr_b16 v[56:57], v14 offset:32768
ds_read_b64_tr_b16 v[58:59], v14 offset:33792
s_waitcnt lgkmcnt(6)
v_mfma_f32_32x32x16_bf16 v[40:55], v[60:63], v[96:99], v[40:55]
s_add_u32 s58, s58, 4096
buffer_load_dwordx4 v[120:123], v2, s[44:47], s58 offen offset:0 sc1
ds_read_b64_tr_b16 v[60:61], v15 offset:32768
ds_read_b64_tr_b16 v[62:63], v15 offset:33792
s_waitcnt vmcnt(5)
s_waitcnt lgkmcnt(6)
v_mfma_f32_32x32x16_bf16 v[24:39], v[64:67], v[100:103], v[24:39]
ds_read_b64_tr_b16 v[64:65], v14 offset:34816
ds_read_b64_tr_b16 v[66:67], v14 offset:35840
s_waitcnt lgkmcnt(6)
v_mfma_f32_32x32x16_bf16 v[40:55], v[68:71], v[100:103], v[40:55]
buffer_load_dwordx4 v[124:127], v2, s[44:47], s58 offen offset:1024 sc1
s_barrier
ds_read_b64_tr_b16 v[68:69], v15 offset:34816
ds_read_b64_tr_b16 v[70:71], v15 offset:35840
s_waitcnt vmcnt(5)
s_waitcnt lgkmcnt(6)
v_mfma_f32_32x32x16_bf16 v[24:39], v[56:59], v[104:107], v[24:39]
ds_read_b64_tr_b16 v[56:57], v16 offset:0
ds_read_b64_tr_b16 v[58:59], v16 offset:1024
s_waitcnt lgkmcnt(6)
v_mfma_f32_32x32x16_bf16 v[40:55], v[60:63], v[104:107], v[40:55]
buffer_load_dwordx4 v[128:131], v2, s[44:47], s58 offen offset:2048 sc1
ds_read_b64_tr_b16 v[60:61], v17 offset:0
ds_read_b64_tr_b16 v[62:63], v17 offset:1024
s_waitcnt vmcnt(5)
s_waitcnt lgkmcnt(6)
v_mfma_f32_32x32x16_bf16 v[24:39], v[64:67], v[108:111], v[24:39]
ds_read_b64_tr_b16 v[64:65], v16 offset:2048
ds_read_b64_tr_b16 v[66:67], v16 offset:3072
s_waitcnt lgkmcnt(6)
v_mfma_f32_32x32x16_bf16 v[40:55], v[68:71], v[108:111], v[40:55]
buffer_load_dwordx4 v[132:135], v2, s[44:47], s58 offen offset:3072 sc1
ds_read_b64_tr_b16 v[68:69], v17 offset:2048
ds_read_b64_tr_b16 v[70:71], v17 offset:3072
s_waitcnt vmcnt(5)
s_waitcnt lgkmcnt(6)
v_mfma_f32_32x32x16_bf16 v[24:39], v[56:59], v[112:115], v[24:39]
ds_read_b64_tr_b16 v[56:57], v16 offset:16384
ds_read_b64_tr_b16 v[58:59], v16 offset:17408
s_waitcnt lgkmcnt(6)
v_mfma_f32_32x32x16_bf16 v[40:55], v[60:63], v[112:115], v[40:55]
s_add_u32 s58, s58, 4096
buffer_load_dwordx4 v[136:139], v2, s[44:47], s58 offen offset:0 sc1
ds_read_b64_tr_b16 v[60:61], v17 offset:16384
ds_read_b64_tr_b16 v[62:63], v17 offset:17408
s_waitcnt vmcnt(5)
s_waitcnt lgkmcnt(6)
v_mfma_f32_32x32x16_bf16 v[24:39], v[64:67], v[116:119], v[24:39]
ds_read_b64_tr_b16 v[64:65], v16 offset:18432
ds_read_b64_tr_b16 v[66:67], v16 offset:19456
s_waitcnt lgkmcnt(6)
v_mfma_f32_32x32x16_bf16 v[40:55], v[68:71], v[116:119], v[40:55]
buffer_load_dwordx4 v[140:143], v2, s[44:47], s58 offen offset:1024 sc1
s_barrier
ds_read_b64_tr_b16 v[68:69], v17 offset:18432
ds_read_b64_tr_b16 v[70:71], v17 offset:19456
s_waitcnt vmcnt(5)
s_waitcnt lgkmcnt(6)
v_mfma_f32_32x32x16_bf16 v[24:39], v[56:59], v[120:123], v[24:39]
ds_read_b64_tr_b16 v[56:57], v14 offset:0
ds_read_b64_tr_b16 v[58:59], v14 offset:1024
s_waitcnt lgkmcnt(6)
v_mfma_f32_32x32x16_bf16 v[40:55], v[60:63], v[120:123], v[40:55]
buffer_load_dwordx4 v[144:147], v2, s[44:47], s58 offen offset:2048 sc1
ds_read_b64_tr_b16 v[60:61], v15 offset:0
ds_read_b64_tr_b16 v[62:63], v15 offset:1024
s_waitcnt vmcnt(5)
s_waitcnt lgkmcnt(6)
v_mfma_f32_32x32x16_bf16 v[24:39], v[64:67], v[124:127], v[24:39]
ds_read_b64_tr_b16 v[64:65], v14 offset:2048
ds_read_b64_tr_b16 v[66:67], v14 offset:3072
s_waitcnt lgkmcnt(6)
v_mfma_f32_32x32x16_bf16 v[40:55], v[68:71], v[124:127], v[40:55]
buffer_load_dwordx4 v[148:151], v2, s[44:47], s58 offen offset:3072 sc1
ds_read_b64_tr_b16 v[68:69], v15 offset:2048
ds_read_b64_tr_b16 v[70:71], v15 offset:3072
s_waitcnt vmcnt(5)
s_waitcnt lgkmcnt(6)
v_mfma_f32_32x32x16_bf16 v[24:39], v[56:59], v[128:131], v[24:39]
ds_read_b64_tr_b16 v[56:57], v18 offset:0
ds_read_b64_tr_b16 v[58:59], v18 offset:1024
s_waitcnt lgkmcnt(6)
v_mfma_f32_32x32x16_bf16 v[40:55], v[60:63], v[128:131], v[40:55]
s_add_u32 s58, s58, 4096
buffer_load_dwordx4 v[72:75], v2, s[44:47], s58 offen offset:0 sc1
ds_read_b64_tr_b16 v[60:61], v19 offset:0
ds_read_b64_tr_b16 v[62:63], v19 offset:1024
s_waitcnt vmcnt(5)
s_waitcnt lgkmcnt(6)
v_mfma_f32_32x32x16_bf16 v[24:39], v[64:67], v[132:135], v[24:39]
ds_read_b64_tr_b16 v[64:65], v18 offset:2048
ds_read_b64_tr_b16 v[66:67], v18 offset:3072
s_waitcnt lgkmcnt(6)
v_mfma_f32_32x32x16_bf16 v[40:55], v[68:71], v[132:135], v[40:55]
buffer_load_dwordx4 v[76:79], v2, s[44:47], s58 offen offset:1024 sc1
s_barrier
ds_read_b64_tr_b16 v[68:69], v19 offset:2048
ds_read_b64_tr_b16 v[70:71], v19 offset:3072
s_waitcnt vmcnt(5)
s_waitcnt lgkmcnt(6)
v_mfma_f32_32x32x16_bf16 v[24:39], v[56:59], v[136:139], v[24:39]
ds_read_b64_tr_b16 v[56:57], v14 offset:49152
ds_read_b64_tr_b16 v[58:59], v14 offset:50176
s_waitcnt lgkmcnt(6)
v_mfma_f32_32x32x16_bf16 v[40:55], v[60:63], v[136:139], v[40:55]
buffer_load_dwordx4 v[80:83], v2, s[44:47], s58 offen offset:2048 sc1
ds_read_b64_tr_b16 v[60:61], v15 offset:49152
ds_read_b64_tr_b16 v[62:63], v15 offset:50176
s_waitcnt vmcnt(5)
s_waitcnt lgkmcnt(6)
v_mfma_f32_32x32x16_bf16 v[24:39], v[64:67], v[140:143], v[24:39]
ds_read_b64_tr_b16 v[64:65], v14 offset:51200
ds_read_b64_tr_b16 v[66:67], v14 offset:52224
s_waitcnt lgkmcnt(6)
v_mfma_f32_32x32x16_bf16 v[40:55], v[68:71], v[140:143], v[40:55]
buffer_load_dwordx4 v[84:87], v2, s[44:47], s58 offen offset:3072 sc1
ds_read_b64_tr_b16 v[68:69], v15 offset:51200
ds_read_b64_tr_b16 v[70:71], v15 offset:52224
s_waitcnt vmcnt(5)
s_waitcnt lgkmcnt(6)
v_mfma_f32_32x32x16_bf16 v[24:39], v[56:59], v[144:147], v[24:39]
ds_read_b64_tr_b16 v[56:57], v16 offset:32768
ds_read_b64_tr_b16 v[58:59], v16 offset:33792
s_waitcnt lgkmcnt(6)
v_mfma_f32_32x32x16_bf16 v[40:55], v[60:63], v[144:147], v[40:55]
s_add_u32 s58, s58, 4096
buffer_load_dwordx4 v[88:91], v2, s[44:47], s58 offen offset:0 sc1
ds_read_b64_tr_b16 v[60:61], v17 offset:32768
ds_read_b64_tr_b16 v[62:63], v17 offset:33792
s_waitcnt vmcnt(5)
s_waitcnt lgkmcnt(6)
v_mfma_f32_32x32x16_bf16 v[24:39], v[64:67], v[148:151], v[24:39]
ds_read_b64_tr_b16 v[64:65], v16 offset:34816
ds_read_b64_tr_b16 v[66:67], v16 offset:35840
s_waitcnt lgkmcnt(6)
v_mfma_f32_32x32x16_bf16 v[40:55], v[68:71], v[148:151], v[40:55]
buffer_load_dwordx4 v[92:95], v2, s[44:47], s58 offen offset:1024 sc1
s_barrier
ds_read_b64_tr_b16 v[68:69], v17 offset:34816
ds_read_b64_tr_b16 v[70:71], v17 offset:35840
s_waitcnt vmcnt(5)
s_waitcnt lgkmcnt(6)
v_mfma_f32_32x32x16_bf16 v[24:39], v[56:59], v[72:75], v[24:39]
ds_read_b64_tr_b16 v[56:57], v14 offset:16384
ds_read_b64_tr_b16 v[58:59], v14 offset:17408
s_waitcnt lgkmcnt(6)
v_mfma_f32_32x32x16_bf16 v[40:55], v[60:63], v[72:75], v[40:55]
buffer_load_dwordx4 v[96:99], v2, s[44:47], s58 offen offset:2048 sc1
ds_read_b64_tr_b16 v[60:61], v15 offset:16384
ds_read_b64_tr_b16 v[62:63], v15 offset:17408
s_waitcnt vmcnt(5)
s_waitcnt lgkmcnt(6)
v_mfma_f32_32x32x16_bf16 v[24:39], v[64:67], v[76:79], v[24:39]
ds_read_b64_tr_b16 v[64:65], v14 offset:18432
ds_read_b64_tr_b16 v[66:67], v14 offset:19456
s_waitcnt lgkmcnt(6)
v_mfma_f32_32x32x16_bf16 v[40:55], v[68:71], v[76:79], v[40:55]
buffer_load_dwordx4 v[100:103], v2, s[44:47], s58 offen offset:3072 sc1
ds_read_b64_tr_b16 v[68:69], v15 offset:18432
ds_read_b64_tr_b16 v[70:71], v15 offset:19456
s_waitcnt vmcnt(5)
s_waitcnt lgkmcnt(6)
v_mfma_f32_32x32x16_bf16 v[24:39], v[56:59], v[80:83], v[24:39]
ds_read_b64_tr_b16 v[56:57], v16 offset:49152
ds_read_b64_tr_b16 v[58:59], v16 offset:50176
s_waitcnt lgkmcnt(6)
v_mfma_f32_32x32x16_bf16 v[40:55], v[60:63], v[80:83], v[40:55]
ds_read_b64_tr_b16 v[60:61], v17 offset:49152
ds_read_b64_tr_b16 v[62:63], v17 offset:50176
s_waitcnt vmcnt(4)
s_waitcnt lgkmcnt(6)
v_mfma_f32_32x32x16_bf16 v[24:39], v[64:67], v[84:87], v[24:39]
ds_read_b64_tr_b16 v[64:65], v16 offset:51200
ds_read_b64_tr_b16 v[66:67], v16 offset:52224
s_waitcnt lgkmcnt(6)
v_mfma_f32_32x32x16_bf16 v[40:55], v[68:71], v[84:87], v[40:55]
s_barrier
ds_read_b64_tr_b16 v[68:69], v17 offset:51200
ds_read_b64_tr_b16 v[70:71], v17 offset:52224
s_waitcnt vmcnt(3)
s_waitcnt lgkmcnt(6)
v_mfma_f32_32x32x16_bf16 v[24:39], v[56:59], v[88:91], v[24:39]
ds_read_b64_tr_b16 v[56:57], v14 offset:32768
ds_read_b64_tr_b16 v[58:59], v14 offset:33792
s_waitcnt lgkmcnt(6)
v_mfma_f32_32x32x16_bf16 v[40:55], v[60:63], v[88:91], v[40:55]
ds_read_b64_tr_b16 v[60:61], v15 offset:32768
ds_read_b64_tr_b16 v[62:63], v15 offset:33792
s_waitcnt vmcnt(2)
s_waitcnt lgkmcnt(6)
v_mfma_f32_32x32x16_bf16 v[24:39], v[64:67], v[92:95], v[24:39]
ds_read_b64_tr_b16 v[64:65], v14 offset:34816
ds_read_b64_tr_b16 v[66:67], v14 offset:35840
s_waitcnt lgkmcnt(6)
v_mfma_f32_32x32x16_bf16 v[40:55], v[68:71], v[92:95], v[40:55]
ds_read_b64_tr_b16 v[68:69], v15 offset:34816
ds_read_b64_tr_b16 v[70:71], v15 offset:35840
s_waitcnt vmcnt(1)
s_waitcnt lgkmcnt(6)
v_mfma_f32_32x32x16_bf16 v[24:39], v[56:59], v[96:99], v[24:39]
s_waitcnt lgkmcnt(4)
v_mfma_f32_32x32x16_bf16 v[40:55], v[60:63], v[96:99], v[40:55]
s_waitcnt vmcnt(0)
s_waitcnt lgkmcnt(2)
v_mfma_f32_32x32x16_bf16 v[24:39], v[64:67], v[100:103], v[24:39]
s_waitcnt lgkmcnt(0)
v_mfma_f32_32x32x16_bf16 v[40:55], v[68:71], v[100:103], v[40:55]
v_lshlrev_b32 v72, 16, v160
v_and_b32 v73, 0xffff0000, v160
v_lshlrev_b32 v74, 16, v161
v_and_b32 v75, 0xffff0000, v161
v_lshlrev_b32 v76, 16, v162
v_and_b32 v77, 0xffff0000, v162
v_lshlrev_b32 v78, 16, v163
v_and_b32 v79, 0xffff0000, v163
s_xor_b32 s56, s3, 2
s_lshl_b32 s56, s56, 11
s_add_u32 s56, s56, 0
v_add_u32 v4, s56, v2
ds_write_b128 v4, v[32:35]
ds_write_b128 v4, v[36:39] offset:1024
s_xor_b32 s56, s3, 4
s_lshl_b32 s56, s56, 11
s_add_u32 s56, s56, 16384
v_add_u32 v4, s56, v2
ds_write_b128 v4, v[40:43]
ds_write_b128 v4, v[44:47] offset:1024
s_xor_b32 s56, s3, 6
s_lshl_b32 s56, s56, 11
s_add_u32 s56, s56, 49152
v_add_u32 v4, s56, v2
ds_write_b128 v4, v[48:51]
ds_write_b128 v4, v[52:55] offset:1024
s_lshl_b32 s56, s3, 11
v_add_u32 v3, s56, v2
v_add_u32 v4, 0, v3
v_add_u32 v5, 16384, v3
v_add_u32 v3, 49152, v3
s_waitcnt lgkmcnt(0)
s_barrier
ds_read_b128 v[32:35], v4
ds_read_b128 v[36:39], v4 offset:1024
ds_read_b128 v[40:43], v5
ds_read_b128 v[44:47], v5 offset:1024
ds_read_b128 v[48:51], v3
ds_read_b128 v[52:55], v3 offset:1024
v_pk_add_f32 v[24:25], v[24:25], v[72:73]
v_pk_add_f32 v[26:27], v[26:27], v[74:75]
v_pk_add_f32 v[28:29], v[28:29], v[76:77]
v_pk_add_f32 v[30:31], v[30:31], v[78:79]
v_add_u32 v20, 155648, v21
v_xor_b32 v21, 16, v20
s_lshl_b32 s56, s3, 10
s_add_u32 s56, s56, 155648
v_add_u32 v22, s56, v2
v_lshrrev_b32 v4, 3, v1
v_and_b32 v3, 7, v1
v_xor_b32 v3, v3, v4
v_lshlrev_b32 v23, 10, v4
v_lshl_add_u32 v23, v3, 4, v23
s_lshl_b32 s56, s6, 6
s_lshl_b32 s57, s3, 3
s_add_u32 s56, s56, s57
s_lshl_b32 s56, s56, 10
s_lshl_b32 s57, s7, 7
s_add_u32 s56, s56, s57
s_waitcnt lgkmcnt(0)
v_pk_add_f32 v[32:33], v[32:33], v[40:41]
v_pk_add_f32 v[34:35], v[34:35], v[42:43]
v_pk_add_f32 v[36:37], v[36:37], v[44:45]
v_pk_add_f32 v[38:39], v[38:39], v[46:47]
v_pk_add_f32 v[24:25], v[24:25], v[48:49]
v_pk_add_f32 v[26:27], v[26:27], v[50:51]
v_pk_add_f32 v[28:29], v[28:29], v[52:53]
v_pk_add_f32 v[30:31], v[30:31], v[54:55]
v_pk_add_f32 v[24:25], v[24:25], v[32:33]
v_pk_add_f32 v[26:27], v[26:27], v[34:35]
v_pk_add_f32 v[28:29], v[28:29], v[36:37]
v_pk_add_f32 v[30:31], v[30:31], v[38:39]
v_cvt_pk_bf16_f32 v80, v24, v25
v_cvt_pk_bf16_f32 v81, v26, v27
v_cvt_pk_bf16_f32 v82, v28, v29
v_cvt_pk_bf16_f32 v83, v30, v31
ds_write_b64 v20, v[80:81]
ds_write_b64 v21, v[82:83]
s_waitcnt lgkmcnt(0)
s_barrier
ds_read_b128 v[80:83], v22
s_waitcnt lgkmcnt(0)
buffer_store_dwordx4 v[80:83], v23, s[80:83], s56 offen
s_endpgm
L_helper:
s_nop 4
s_setprio 3
s_mul_i32 s70, s3, 20
s_lshl_b32 s56, s6, 6
s_sub_u32 s56, s56, 16
s_add_u32 s56, s56, s70
s_lshl_b32 s71, s56, 10
s_lshl_b32 s72, s70, 9
s_add_u32 s72, s72, 73728
v_lshrrev_b32 v5, 5, v1
v_and_b32 v3, 31, v1
v_xor_b32 v3, v3, v5
v_lshlrev_b32 v3, 4, v3
v_lshl_add_u32 v3, v5, 10, v3
s_waitcnt lgkmcnt(0)
s_mov_b32 s36, s16
s_mov_b32 s37, s17
s_mov_b32 s38, 2097152
s_mov_b32 s39, 0x00020000
v_mov_b32 v27, v3
s_add_u32 s56, s70, 0
s_and_b32 s56, s56, 14
s_lshl_b32 s56, s56, 4
v_xor_b32 v4, s56, v27
s_add_u32 m0, s72, 0
s_add_u32 s57, s71, 0
buffer_load_dwordx4 v4, s[36:39], s57 offen lds
s_add_u32 s56, s70, 2
s_and_b32 s56, s56, 14
s_lshl_b32 s56, s56, 4
v_xor_b32 v4, s56, v27
s_add_u32 m0, s72, 1024
s_add_u32 s57, s71, 2048
buffer_load_dwordx4 v4, s[36:39], s57 offen lds
s_add_u32 s56, s70, 4
s_and_b32 s56, s56, 14
s_lshl_b32 s56, s56, 4
v_xor_b32 v4, s56, v27
s_add_u32 m0, s72, 2048
s_add_u32 s57, s71, 4096
buffer_load_dwordx4 v4, s[36:39], s57 offen lds
s_add_u32 s56, s70, 6
s_and_b32 s56, s56, 14
s_lshl_b32 s56, s56, 4
v_xor_b32 v4, s56, v27
s_add_u32 m0, s72, 3072
s_add_u32 s57, s71, 6144
buffer_load_dwordx4 v4, s[36:39], s57 offen lds
s_add_u32 s56, s70, 8
s_and_b32 s56, s56, 14
s_lshl_b32 s56, s56, 4
v_xor_b32 v4, s56, v27
s_add_u32 m0, s72, 4096
s_add_u32 s57, s71, 8192
buffer_load_dwordx4 v4, s[36:39], s57 offen lds
s_add_u32 s56, s70, 10
s_and_b32 s56, s56, 14
s_lshl_b32 s56, s56, 4
v_xor_b32 v4, s56, v27
s_add_u32 m0, s72, 5120
s_add_u32 s57, s71, 10240
buffer_load_dwordx4 v4, s[36:39], s57 offen lds
s_add_u32 s56, s70, 12
s_and_b32 s56, s56, 14
s_lshl_b32 s56, s56, 4
v_xor_b32 v4, s56, v27
s_add_u32 m0, s72, 6144
s_add_u32 s57, s71, 12288
buffer_load_dwordx4 v4, s[36:39], s57 offen lds
s_add_u32 s56, s70, 14
s_and_b32 s56, s56, 14
s_lshl_b32 s56, s56, 4
v_xor_b32 v4, s56, v27
s_add_u32 m0, s72, 7168
s_add_u32 s57, s71, 14336
buffer_load_dwordx4 v4, s[36:39], s57 offen lds
s_add_u32 s56, s70, 16
s_and_b32 s56, s56, 14
s_lshl_b32 s56, s56, 4
v_xor_b32 v4, s56, v27
s_add_u32 m0, s72, 8192
s_add_u32 s57, s71, 16384
buffer_load_dwordx4 v4, s[36:39], s57 offen lds
s_add_u32 s56, s70, 18
s_and_b32 s56, s56, 14
s_lshl_b32 s56, s56, 4
v_xor_b32 v4, s56, v27
s_add_u32 m0, s72, 9216
s_add_u32 s57, s71, 18432
buffer_load_dwordx4 v4, s[36:39], s57 offen lds
s_mov_b32 s40, s18
s_mov_b32 s41, s19
s_mov_b32 s42, 1572864
s_mov_b32 s43, 0x00020000
v_lshrrev_b32 v4, 3, v1
v_mul_u32_u24 v5, 3072, v4
v_lshlrev_b32 v9, 10, v4
v_mul_u32_u24 v13, 3584, v4
v_and_b32 v3, 7, v1
v_xor_b32 v12, v3, v4
v_lshl_add_u32 v12, v12, 4, v9
v_bfe_u32 v4, v1, 4, 1
v_lshlrev_b32 v6, 1, v4
v_xor_b32 v6, v6, v3
v_lshl_add_u32 v8, v6, 4, v5
s_lshl_b32 s56, s8, 6
v_xor_b32 v8, s56, v8
v_lshl_add_u32 v13, v6, 4, v13
v_xor_b32 v13, s56, v13
v_lshlrev_b32 v6, 2, v4
v_xor_b32 v6, v6, v3
v_lshl_add_u32 v9, v6, 4, v9
s_mul_i32 s60, s3, 24576
s_lshl_b32 s56, s7, 7
s_add_u32 s60, s60, s56
s_lshl_b32 s61, s3, 10
s_add_u32 m0, s61, 65536
s_add_u32 s56, s60, 1024
buffer_load_dwordx4 v8, s[40:43], s56 offen lds
s_add_u32 m0, s61, 69632
s_add_u32 s56, s60, 99328
buffer_load_dwordx4 v8, s[40:43], s56 offen lds
s_add_u32 m0, s61, 57344
s_add_u32 s56, s60, 0
buffer_load_dwordx4 v8, s[40:43], s56 offen lds
s_add_u32 m0, s61, 61440
s_add_u32 s56, s60, 98304
buffer_load_dwordx4 v8, s[40:43], s56 offen lds
s_add_u32 m0, s61, 49152
s_add_u32 s56, s60, 2048
buffer_load_dwordx4 v8, s[40:43], s56 offen lds
s_add_u32 m0, s61, 53248
s_add_u32 s56, s60, 100352
buffer_load_dwordx4 v8, s[40:43], s56 offen lds
s_add_u32 m0, s61, 40960
s_add_u32 s56, s60, 197632
buffer_load_dwordx4 v8, s[40:43], s56 offen lds
s_add_u32 m0, s61, 45056
s_add_u32 s56, s60, 295936
buffer_load_dwordx4 v8, s[40:43], s56 offen lds
s_add_u32 m0, s61, 32768
s_add_u32 s56, s60, 196608
buffer_load_dwordx4 v8, s[40:43], s56 offen lds
s_add_u32 m0, s61, 36864
s_add_u32 s56, s60, 294912
buffer_load_dwordx4 v8, s[40:43], s56 offen lds
s_add_u32 m0, s61, 24576
s_add_u32 s56, s60, 198656
buffer_load_dwordx4 v8, s[40:43], s56 offen lds
s_add_u32 m0, s61, 28672
s_add_u32 s56, s60, 296960
buffer_load_dwordx4 v8, s[40:43], s56 offen lds
s_mov_b32 s44, s34
s_mov_b32 s45, s35
s_mov_b32 s46, 16777216
s_mov_b32 s47, 0x00020000
s_mov_b32 s48, s20
s_mov_b32 s49, s21
s_mov_b32 s50, 524288
s_mov_b32 s51, 0x00020000
s_mov_b32 s76, s28
s_mov_b32 s77, s29
s_mov_b32 s78, 1835008
s_mov_b32 s79, 0x00020000
s_mov_b32 s84, s32
s_mov_b32 s85, s33
s_mov_b32 s86, 256
s_mov_b32 s87, 0x00020000
s_mov_b32 s88, s24
s_mov_b32 s89, s25
s_mov_b32 s90, 1835008
s_mov_b32 s91, 0x00020000
s_mov_b32 s92, s26
s_mov_b32 s93, s27
s_mov_b32 s94, 1835008
s_mov_b32 s95, 0x00020000
s_cmp_eq_u32 s8, 0
s_cselect_b32 s52, s24, s26
s_cselect_b32 s53, s25, s27
s_mov_b32 s54, 1835008
s_mov_b32 s55, 0x00020000
s_lshl_b32 s56, s7, 7
s_lshl_b32 s57, s9, 7
s_lshl_b32 s58, s8, 4
s_add_u32 s57, s57, s58
s_lshl_b32 s62, s57, 10
s_add_u32 s62, s62, s56
s_mul_i32 s57, s9, 448
s_add_u32 s57, s57, s58
s_lshl_b32 s64, s57, 10
s_add_u32 s64, s64, s56
s_lshl_b32 s63, s3, 11
s_lshl_b32 s56, s8, 1
v_lshrrev_b32 v4, 2, v1
v_mul_u32_u24 v10, 3584, v4
v_and_b32 v4, 3, v1
v_xor_b32 v4, s56, v4
v_lshl_add_u32 v10, v4, 4, v10
v_lshrrev_b32 v4, 1, v1
s_lshl_b32 s56, s8, 2
v_xor_b32 v4, s56, v4
v_mul_u32_u24 v11, 3584, v4
v_and_b32 v4, 1, v1
v_lshl_add_u32 v11, v4, 4, v11
s_lshl_b32 s73, s8, 12
s_lshl_b32 s56, s9, 10
s_add_u32 s73, s73, s56
s_lshr_b32 s56, s12, 2
s_mul_i32 s56, s56, 896
s_mul_i32 s57, s9, 28672
s_and_b32 s58, s12, 3
s_lshl_b32 s59, s58, 8
s_add_u32 s65, s56, s57
s_add_u32 s65, s65, s59
s_and_b32 s59, s14, 0xff
s_lshl_b32 s59, s59, 5
s_lshl_b32 s57, s57, 1
s_add_u32 s67, s56, s57
s_add_u32 s67, s67, s59
s_lshr_b32 s59, s14, 8
s_lshl_b32 s59, s59, 5
s_lshl_b32 s57, s57, 1
s_add_u32 s66, s56, s57
s_add_u32 s66, s66, s59
v_add_u32 v14, s73, v2
v_mov_b32 v33, 0
v_mov_b32 v40, 0x3f803f80
v_mov_b32 v41, 0x3f803f80
v_mov_b32 v42, 0x3f803f80
v_mov_b32 v43, 0x3f803f80
v_add_u32 v44, 73728, v2
s_waitcnt vmcnt(12)
s_cmp_lg_u32 s3, 0
s_cbranch_scc1 L_ones_100001
s_mov_b32 exec_hi, 0
ds_write_b128 v44, v[40:43] offset:0
s_mov_b64 exec, -1
L_ones_100001:
s_waitcnt vmcnt(6)
s_waitcnt lgkmcnt(0)
s_barrier
s_add_u32 m0, s61, 16384
s_add_u32 s56, s60, 394240
buffer_load_dwordx4 v8, s[40:43], s56 offen lds
s_add_u32 m0, s61, 20480
s_add_u32 s56, s60, 492544
buffer_load_dwordx4 v8, s[40:43], s56 offen lds
s_add_u32 m0, s61, 8192
s_add_u32 s56, s60, 393216
buffer_load_dwordx4 v8, s[40:43], s56 offen lds
s_add_u32 m0, s61, 12288
s_add_u32 s56, s60, 491520
buffer_load_dwordx4 v8, s[40:43], s56 offen lds
s_add_u32 m0, s61, 0
s_add_u32 s56, s60, 395264
buffer_load_dwordx4 v8, s[40:43], s56 offen lds
s_add_u32 m0, s61, 4096
s_add_u32 s56, s60, 493568
buffer_load_dwordx4 v8, s[40:43], s56 offen lds
s_add_u32 s56, s70, 0
s_and_b32 s56, s56, 14
s_lshl_b32 s56, s56, 4
v_xor_b32 v4, s56, v27
s_add_u32 m0, s72, 40960
s_add_u32 s57, s71, 512
buffer_load_dwordx4 v4, s[36:39], s57 offen lds
s_add_u32 s56, s70, 2
s_and_b32 s56, s56, 14
s_lshl_b32 s56, s56, 4
v_xor_b32 v4, s56, v27
s_add_u32 m0, s72, 41984
s_add_u32 s57, s71, 2560
buffer_load_dwordx4 v4, s[36:39], s57 offen lds
s_add_u32 s56, s70, 4
s_and_b32 s56, s56, 14
s_lshl_b32 s56, s56, 4
v_xor_b32 v4, s56, v27
s_add_u32 m0, s72, 43008
s_add_u32 s57, s71, 4608
buffer_load_dwordx4 v4, s[36:39], s57 offen lds
s_add_u32 s56, s70, 6
s_and_b32 s56, s56, 14
s_lshl_b32 s56, s56, 4
v_xor_b32 v4, s56, v27
s_add_u32 m0, s72, 44032
s_add_u32 s57, s71, 6656
buffer_load_dwordx4 v4, s[36:39], s57 offen lds
s_add_u32 s56, s70, 8
s_and_b32 s56, s56, 14
s_lshl_b32 s56, s56, 4
v_xor_b32 v4, s56, v27
s_add_u32 m0, s72, 45056
s_add_u32 s57, s71, 8704
buffer_load_dwordx4 v4, s[36:39], s57 offen lds
s_add_u32 s56, s70, 10
s_and_b32 s56, s56, 14
s_lshl_b32 s56, s56, 4
v_xor_b32 v4, s56, v27
s_add_u32 m0, s72, 46080
s_add_u32 s57, s71, 10752
buffer_load_dwordx4 v4, s[36:39], s57 offen lds
s_add_u32 s56, s70, 12
s_and_b32 s56, s56, 14
s_lshl_b32 s56, s56, 4
v_xor_b32 v4, s56, v27
s_add_u32 m0, s72, 47104
s_add_u32 s57, s71, 12800
buffer_load_dwordx4 v4, s[36:39], s57 offen lds
s_add_u32 s56, s70, 14
s_and_b32 s56, s56, 14
s_lshl_b32 s56, s56, 4
v_xor_b32 v4, s56, v27
s_add_u32 m0, s72, 48128
s_add_u32 s57, s71, 14848
buffer_load_dwordx4 v4, s[36:39], s57 offen lds
s_add_u32 s56, s70, 16
s_and_b32 s56, s56, 14
s_lshl_b32 s56, s56, 4
v_xor_b32 v4, s56, v27
s_add_u32 m0, s72, 49152
s_add_u32 s57, s71, 16896
buffer_load_dwordx4 v4, s[36:39], s57 offen lds
s_add_u32 s56, s70, 18
s_and_b32 s56, s56, 14
s_lshl_b32 s56, s56, 4
v_xor_b32 v4, s56, v27
s_add_u32 m0, s72, 50176
s_add_u32 s57, s71, 18944
buffer_load_dwordx4 v4, s[36:39], s57 offen lds
buffer_load_dwordx2 v[30:31], v33, s[84:87], 0 offen sc1
s_waitcnt vmcnt(17)
s_waitcnt lgkmcnt(0)
s_barrier
s_add_u32 m0, s61, 65536
s_add_u32 s56, s60, 590848
buffer_load_dwordx4 v8, s[40:43], s56 offen lds
s_add_u32 m0, s61, 69632
s_add_u32 s56, s60, 689152
buffer_load_dwordx4 v8, s[40:43], s56 offen lds
s_add_u32 m0, s61, 57344
s_add_u32 s56, s60, 589824
buffer_load_dwordx4 v8, s[40:43], s56 offen lds
s_add_u32 m0, s61, 61440
s_add_u32 s56, s60, 688128
buffer_load_dwordx4 v8, s[40:43], s56 offen lds
s_add_u32 m0, s61, 49152
s_add_u32 s56, s60, 591872
buffer_load_dwordx4 v8, s[40:43], s56 offen lds
s_add_u32 m0, s61, 53248
s_add_u32 s56, s60, 690176
buffer_load_dwordx4 v8, s[40:43], s56 offen lds
s_waitcnt vmcnt(17)
s_waitcnt lgkmcnt(0)
s_barrier
s_add_u32 m0, s61, 24576
s_add_u32 s56, s60, 787456
buffer_load_dwordx4 v8, s[40:43], s56 offen lds
s_add_u32 m0, s61, 28672
s_add_u32 s56, s60, 885760
buffer_load_dwordx4 v8, s[40:43], s56 offen lds
s_add_u32 m0, s61, 40960
s_add_u32 s56, s60, 786432
buffer_load_dwordx4 v8, s[40:43], s56 offen lds
s_add_u32 m0, s61, 45056
s_add_u32 s56, s60, 884736
buffer_load_dwordx4 v8, s[40:43], s56 offen lds
s_add_u32 m0, s61, 32768
s_add_u32 s56, s60, 788480
buffer_load_dwordx4 v8, s[40:43], s56 offen lds
s_add_u32 m0, s61, 36864
s_add_u32 s56, s60, 886784
buffer_load_dwordx4 v8, s[40:43], s56 offen lds
s_waitcnt vmcnt(12)
s_mov_b32 s57, 0
L_npoll_100002:
v_readfirstlane_b32 s96, v30
v_readfirstlane_b32 s97, v31
s_cmp_lg_u32 s96, 0
s_cbranch_scc1 L_ndone_100003
s_add_u32 s57, s57, 1
s_cmp_gt_u32 s57, 0x40000
s_cbranch_scc1 L_ndone_100003
buffer_load_dwordx2 v[30:31], v33, s[84:87], 0 offen sc1
s_waitcnt vmcnt(0)
s_branch L_npoll_100002
L_ndone_100003:
s_getreg_b32 s99, hwreg(HW_REG_XCC_ID)
s_and_b32 s99, s99, 7
s_or_b32 s99, s99, s96
s_cmp_lg_u32 s3, 0
s_cbranch_scc1 L_nohello_100004
v_mov_b32 v30, s99
s_lshl_b32 s56, s11, 4
s_add_u32 s56, s56, s12
s_lshl_b32 s56, s56, 3
s_add_u32 s56, s56, 14213120
s_mov_b64 exec, 1
buffer_store_dwordx2 v[30:31], v33, s[44:47], s56 offen sc1
s_mov_b64 exec, -1
L_nohello_100004:
s_waitcnt vmcnt(6)
s_waitcnt lgkmcnt(0)
s_barrier
s_add_u32 m0, s61, 16384
s_add_u32 s56, s60, 984064
buffer_load_dwordx4 v8, s[40:43], s56 offen lds
s_add_u32 m0, s61, 20480
s_add_u32 s56, s60, 1082368
buffer_load_dwordx4 v8, s[40:43], s56 offen lds
s_add_u32 m0, s61, 8192
s_add_u32 s56, s60, 983040
buffer_load_dwordx4 v8, s[40:43], s56 offen lds
s_add_u32 m0, s61, 12288
s_add_u32 s56, s60, 1081344
buffer_load_dwordx4 v8, s[40:43], s56 offen lds
s_add_u32 m0, s61, 0
s_add_u32 s56, s60, 985088
buffer_load_dwordx4 v8, s[40:43], s56 offen lds
s_add_u32 m0, s61, 4096
s_add_u32 s56, s60, 1083392
buffer_load_dwordx4 v8, s[40:43], s56 offen lds
s_cmp_lg_u32 s3, 0
s_cbranch_scc1 L_ones_100005
s_mov_b32 exec_hi, 0
ds_write_b128 v44, v[40:43] offset:40960
s_mov_b64 exec, -1
L_ones_100005:
s_waitcnt vmcnt(6)
s_waitcnt lgkmcnt(0)
s_barrier
s_add_u32 m0, s61, 106496
s_add_u32 s56, s60, 1180672
buffer_load_dwordx4 v8, s[40:43], s56 offen lds
s_add_u32 m0, s61, 110592
s_add_u32 s56, s60, 1278976
buffer_load_dwordx4 v8, s[40:43], s56 offen lds
s_add_u32 m0, s61, 98304
s_add_u32 s56, s60, 1179648
buffer_load_dwordx4 v8, s[40:43], s56 offen lds
s_add_u32 m0, s61, 102400
s_add_u32 s56, s60, 1277952
buffer_load_dwordx4 v8, s[40:43], s56 offen lds
s_add_u32 m0, s61, 90112
s_add_u32 s56, s60, 1181696
buffer_load_dwordx4 v8, s[40:43], s56 offen lds
s_add_u32 m0, s61, 94208
s_add_u32 s56, s60, 1280000
buffer_load_dwordx4 v8, s[40:43], s56 offen lds
s_waitcnt vmcnt(6)
s_waitcnt lgkmcnt(0)
s_barrier
s_add_u32 m0, s61, 81920
s_add_u32 s56, s60, 1377280
buffer_load_dwordx4 v8, s[40:43], s56 offen lds
s_add_u32 m0, s61, 86016
s_add_u32 s56, s60, 1475584
buffer_load_dwordx4 v8, s[40:43], s56 offen lds
s_add_u32 m0, s61, 24576
s_add_u32 s56, s60, 1376256
buffer_load_dwordx4 v8, s[40:43], s56 offen lds
s_add_u32 m0, s61, 28672
s_add_u32 s56, s60, 1474560
buffer_load_dwordx4 v8, s[40:43], s56 offen lds
s_add_u32 m0, s61, 73728
s_add_u32 s56, s60, 1378304
buffer_load_dwordx4 v8, s[40:43], s56 offen lds
s_add_u32 m0, s61, 77824
s_add_u32 s56, s60, 1476608
buffer_load_dwordx4 v8, s[40:43], s56 offen lds
v_lshrrev_b32 v4, 4, v1
v_mul_u32_u24 v3, 3584, v4
v_and_b32 v5, 15, v1
v_lshl_add_u32 v3, v5, 4, v3
v_cmp_gt_u32 vcc, 14, v5
v_mov_b32 v4, 0x7fffffff
s_nop 0
v_cndmask_b32 v3, v4, v3, vcc
s_lshl_b32 s56, s11, 5
s_lshl_b32 s57, s3, 3
s_add_u32 s56, s56, s57
s_mul_i32 s56, s56, 3584
s_mul_i32 s57, s12, 224
s_add_u32 s56, s56, s57
s_add_u32 s57, s56, 14336
buffer_load_dwordx4 v[92:95], v3, s[88:91], s56 offen
buffer_load_dwordx4 v[96:99], v3, s[88:91], s57 offen
buffer_load_dwordx4 v[100:103], v3, s[92:95], s56 offen
buffer_load_dwordx4 v[104:107], v3, s[92:95], s57 offen
v_lshlrev_b32 v32, 3, v5
s_waitcnt vmcnt(10)
s_waitcnt lgkmcnt(0)
s_barrier
s_add_u32 m0, s63, 0
s_add_u32 s56, s62, 0
buffer_load_dwordx4 v9, s[48:51], s56 offen lds
s_add_u32 m0, s63, 1024
s_add_u32 s56, s62, 8192
buffer_load_dwordx4 v9, s[48:51], s56 offen lds
s_add_u32 m0, s63, 8192
s_add_u32 s56, s62, 262144
buffer_load_dwordx4 v9, s[48:51], s56 offen lds
s_add_u32 m0, s63, 9216
s_add_u32 s56, s62, 270336
buffer_load_dwordx4 v9, s[48:51], s56 offen lds
s_add_u32 m0, s63, 32768
s_add_u32 s56, s62, 32768
buffer_load_dwordx4 v9, s[48:51], s56 offen lds
s_add_u32 m0, s63, 33792
s_add_u32 s56, s62, 40960
buffer_load_dwordx4 v9, s[48:51], s56 offen lds
s_lshl_b32 s56, s11, 7
s_add_u32 s101, s56, 14213120
buffer_load_dwordx2 v[30:31], v32, s[44:47], s101 offen sc1
s_waitcnt vmcnt(11)
s_waitcnt lgkmcnt(0)
s_barrier
s_add_u32 m0, s63, 40960
s_add_u32 s56, s62, 294912
buffer_load_dwordx4 v9, s[48:51], s56 offen lds
s_add_u32 m0, s63, 41984
s_add_u32 s56, s62, 303104
buffer_load_dwordx4 v9, s[48:51], s56 offen lds
s_add_u32 m0, s63, 49152
s_add_u32 s56, s62, 65536
buffer_load_dwordx4 v9, s[48:51], s56 offen lds
s_add_u32 m0, s63, 50176
s_add_u32 s56, s62, 73728
buffer_load_dwordx4 v9, s[48:51], s56 offen lds
s_add_u32 m0, s63, 57344
s_add_u32 s56, s62, 327680
buffer_load_dwordx4 v9, s[48:51], s56 offen lds
s_add_u32 m0, s63, 58368
s_add_u32 s56, s62, 335872
buffer_load_dwordx4 v9, s[48:51], s56 offen lds
s_waitcnt vmcnt(6)
s_mov_b32 s57, 0
L_hpoll_100006:
v_and_b32 v34, -8, v30
v_mov_b32 v35, v31
v_cmp_ne_u64 vcc, s[96:97], v[34:35]
s_cbranch_vccz L_hdone_100007
s_add_u32 s57, s57, 1
s_cmp_gt_u32 s57, 0x40000
s_cbranch_scc1 L_hdone_100007
buffer_load_dwordx2 v[30:31], v32, s[44:47], s101 offen sc1
s_waitcnt vmcnt(0)
s_branch L_hpoll_100006
L_hdone_100007:
v_cmp_ne_u32 vcc, s99, v30
s_nop 0
s_cmp_eq_u64 vcc, 0
s_cselect_b32 s98, 1, 0
v_mov_b32 v36, s96
v_mov_b32 v37, s97
v_mov_b32 v38, s98
v_mov_b32 v39, 0
v_mov_b32 v4, 156672
ds_write_b128 v4, v[36:39]
s_waitcnt lgkmcnt(0)
s_barrier
s_add_u32 m0, s63, 16384
s_add_u32 s56, s62, 98304
buffer_load_dwordx4 v9, s[48:51], s56 offen lds
s_add_u32 m0, s63, 17408
s_add_u32 s56, s62, 106496
buffer_load_dwordx4 v9, s[48:51], s56 offen lds
s_add_u32 m0, s63, 24576
s_add_u32 s56, s62, 360448
buffer_load_dwordx4 v9, s[48:51], s56 offen lds
s_add_u32 m0, s63, 25600
s_add_u32 s56, s62, 368640
buffer_load_dwordx4 v9, s[48:51], s56 offen lds
s_lshl_b32 s56, s6, 6
s_lshl_b32 s57, s3, 3
s_add_u32 s56, s56, s57
s_lshl_b32 s56, s56, 10
s_lshl_b32 s57, s7, 7
s_add_u32 s56, s56, s57
s_add_u32 m0, s61, 147456
s_add_u32 s56, s56, 0
buffer_load_dwordx4 v12, s[36:39], s56 offen lds
s_lshl_b32 s56, s6, 6
s_lshl_b32 s57, s3, 3
s_add_u32 s56, s56, s57
s_lshl_b32 s56, s56, 10
s_lshl_b32 s57, s7, 7
s_add_u32 s56, s56, s57
s_add_u32 m0, s61, 151552
s_add_u32 s56, s56, 32768
buffer_load_dwordx4 v12, s[36:39], s56 offen lds
s_add_u32 m0, s73, 139264
s_add_u32 s56, s65, 0
buffer_load_dwordx4 v13, s[52:55], s56 offen lds
s_add_u32 m0, s73, 141312
s_add_u32 s56, s65, 57344
buffer_load_dwordx4 v13, s[52:55], s56 offen lds
s_add_u32 m0, s73, 131072
s_add_u32 s56, s67, 0
buffer_load_dwordx4 v10, s[52:55], s56 offen lds
s_add_u32 m0, s73, 133120
s_add_u32 s56, s67, 114688
buffer_load_dwordx4 v10, s[52:55], s56 offen lds
s_add_u32 m0, s73, 122880
s_add_u32 s56, s66, 0
buffer_load_dwordx4 v11, s[52:55], s56 offen lds
s_add_u32 m0, s73, 124928
s_add_u32 s56, s66, 229376
buffer_load_dwordx4 v11, s[52:55], s56 offen lds
s_add_u32 m0, s73, 114688
s_add_u32 s56, s65, 114688
buffer_load_dwordx4 v13, s[52:55], s56 offen lds
s_add_u32 m0, s73, 116736
s_add_u32 s56, s65, 172032
buffer_load_dwordx4 v13, s[52:55], s56 offen lds
s_add_u32 m0, s73, 106496
s_add_u32 s56, s65, 229376
buffer_load_dwordx4 v13, s[52:55], s56 offen lds
s_add_u32 m0, s73, 108544
s_add_u32 s56, s65, 286720
buffer_load_dwordx4 v13, s[52:55], s56 offen lds
s_add_u32 m0, s73, 98304
s_add_u32 s56, s67, 229376
buffer_load_dwordx4 v10, s[52:55], s56 offen lds
s_add_u32 m0, s73, 100352
s_add_u32 s56, s67, 344064
buffer_load_dwordx4 v10, s[52:55], s56 offen lds
v_lshlrev_b32 v4, 16, v92
v_lshlrev_b32 v5, 16, v96
v_and_b32 v3, 0xffff0000, v92
v_and_b32 v6, 0xffff0000, v96
v_add_f32 v40, v4, v5
v_add_f32 v41, v3, v6
v_lshlrev_b32 v4, 16, v93
v_lshlrev_b32 v5, 16, v97
v_and_b32 v3, 0xffff0000, v93
v_and_b32 v6, 0xffff0000, v97
v_add_f32 v42, v4, v5
v_add_f32 v43, v3, v6
v_lshlrev_b32 v4, 16, v94
v_lshlrev_b32 v5, 16, v98
v_and_b32 v3, 0xffff0000, v94
v_and_b32 v6, 0xffff0000, v98
v_add_f32 v44, v4, v5
v_add_f32 v45, v3, v6
v_lshlrev_b32 v4, 16, v95
v_lshlrev_b32 v5, 16, v99
v_and_b32 v3, 0xffff0000, v95
v_and_b32 v6, 0xffff0000, v99
v_add_f32 v46, v4, v5
v_add_f32 v47, v3, v6
v_lshlrev_b32 v4, 16, v100
v_lshlrev_b32 v5, 16, v104
v_and_b32 v3, 0xffff0000, v100
v_and_b32 v6, 0xffff0000, v104
v_add_f32 v48, v4, v5
v_add_f32 v49, v3, v6
v_lshlrev_b32 v4, 16, v101
v_lshlrev_b32 v5, 16, v105
v_and_b32 v3, 0xffff0000, v101
v_and_b32 v6, 0xffff0000, v105
v_add_f32 v50, v4, v5
v_add_f32 v51, v3, v6
v_lshlrev_b32 v4, 16, v102
v_lshlrev_b32 v5, 16, v106
v_and_b32 v3, 0xffff0000, v102
v_and_b32 v6, 0xffff0000, v106
v_add_f32 v52, v4, v5
v_add_f32 v53, v3, v6
v_lshlrev_b32 v4, 16, v103
v_lshlrev_b32 v5, 16, v107
v_and_b32 v3, 0xffff0000, v103
v_and_b32 v6, 0xffff0000, v107
v_add_f32 v54, v4, v5
v_add_f32 v55, v3, v6
v_permlane32_swap_b32 v40, v48
v_permlane32_swap_b32 v41, v49
v_permlane32_swap_b32 v42, v50
v_permlane32_swap_b32 v43, v51
v_permlane32_swap_b32 v44, v52
v_permlane32_swap_b32 v45, v53
v_permlane32_swap_b32 v46, v54
v_permlane32_swap_b32 v47, v55
v_add_f32 v40, v40, v48
v_add_f32 v41, v41, v49
v_add_f32 v42, v42, v50
v_add_f32 v43, v43, v51
v_add_f32 v44, v44, v52
v_add_f32 v45, v45, v53
v_add_f32 v46, v46, v54
v_add_f32 v47, v47, v55
v_permlane16_swap_b32 v40, v44
v_permlane16_swap_b32 v41, v45
v_permlane16_swap_b32 v42, v46
v_permlane16_swap_b32 v43, v47
v_add_f32 v40, v40, v44
v_add_f32 v41, v41, v45
v_add_f32 v42, v42, v46
v_add_f32 v43, v43, v47
v_bfe_u32 v4, v1, 1, 3
v_lshlrev_b32 v4, 7, v4
v_lshrrev_b32 v5, 5, v1
v_lshl_add_u32 v4, v5, 6, v4
v_and_b32 v5, 1, v1
v_lshl_add_u32 v4, v5, 5, v4
v_bfe_u32 v5, v1, 4, 1
v_lshl_add_u32 v4, v5, 4, v4
s_add_u32 s56, s61, 157696
v_add_u32 v4, s56, v4
ds_write_b128 v4, v[40:43]
s_waitcnt vmcnt(12)
s_waitcnt lgkmcnt(0)
s_barrier
s_add_u32 m0, s73, 90112
s_add_u32 s56, s65, 344064
buffer_load_dwordx4 v13, s[52:55], s56 offen lds
s_add_u32 m0, s73, 92160
s_add_u32 s56, s65, 401408
buffer_load_dwordx4 v13, s[52:55], s56 offen lds
s_add_u32 m0, s73, 81920
s_add_u32 s56, s65, 458752
buffer_load_dwordx4 v13, s[52:55], s56 offen lds
s_add_u32 m0, s73, 83968
s_add_u32 s56, s65, 516096
buffer_load_dwordx4 v13, s[52:55], s56 offen lds
s_add_u32 m0, s73, 73728
s_add_u32 s56, s67, 458752
buffer_load_dwordx4 v10, s[52:55], s56 offen lds
s_add_u32 m0, s73, 75776
s_add_u32 s56, s67, 573440
buffer_load_dwordx4 v10, s[52:55], s56 offen lds
s_add_u32 m0, s73, 65536
s_add_u32 s56, s66, 458752
buffer_load_dwordx4 v11, s[52:55], s56 offen lds
s_add_u32 m0, s73, 67584
s_add_u32 s56, s66, 688128
buffer_load_dwordx4 v11, s[52:55], s56 offen lds
v_and_b32 v4, 255, v0
v_lshlrev_b32 v26, 2, v4
v_add_u32 v5, 157696, v26
ds_read_b32 v40, v5 offset:0
ds_read_b32 v41, v5 offset:1024
ds_read_b32 v42, v5 offset:2048
ds_read_b32 v43, v5 offset:3072
v_cmp_gt_u32 vcc, 224, v4
v_mov_b32 v5, 0x7fffffff
s_nop 0
v_cndmask_b32 v4, v5, v26, vcc
s_lshl_b32 s56, s11, 4
s_add_u32 s56, s56, s12
s_mul_i32 s56, s56, 896
s_add_u32 s56, s56, 13631488
s_waitcnt lgkmcnt(0)
v_add_f32 v40, v40, v41
v_add_f32 v42, v42, v43
v_add_f32 v40, v40, v42
buffer_store_dword v40, v4, s[44:47], s56 offen sc1
s_lshl_b32 s56, s12, 9
s_lshl_b32 s57, s13, 3
s_add_u32 s56, s56, s57
s_add_u32 s56, s56, 14204928
v_mov_b32 v4, s96
v_mov_b32 v5, s97
s_waitcnt vmcnt(0)
s_mov_b64 exec, 1
buffer_store_dwordx2 v[4:5], v33, s[44:47], s56 offen sc1
s_mov_b64 exec, -1
s_barrier
s_barrier
s_waitcnt lgkmcnt(0)
s_barrier
s_add_u32 m0, s73, 147456
s_add_u32 s56, s65, 573440
buffer_load_dwordx4 v13, s[52:55], s56 offen lds
s_add_u32 m0, s73, 149504
s_add_u32 s56, s65, 630784
buffer_load_dwordx4 v13, s[52:55], s56 offen lds
s_add_u32 m0, s73, 57344
s_add_u32 s56, s65, 688128
buffer_load_dwordx4 v13, s[52:55], s56 offen lds
s_add_u32 m0, s73, 59392
s_add_u32 s56, s65, 745472
buffer_load_dwordx4 v13, s[52:55], s56 offen lds
s_add_u32 m0, s73, 49152
s_add_u32 s56, s67, 688128
buffer_load_dwordx4 v10, s[52:55], s56 offen lds
s_add_u32 m0, s73, 51200
s_add_u32 s56, s67, 802816
buffer_load_dwordx4 v10, s[52:55], s56 offen lds
s_lshl_b32 s70, s4, 11
s_lshl_b32 s71, s13, 15
s_add_u32 s71, s71, 2097152
s_barrier
s_add_u32 m0, s70, 32768
s_add_u32 s56, s71, 8192
buffer_load_dwordx4 v2, s[44:47], s56 offen sc1 lds
buffer_load_dwordx4 v2, s[44:47], s56 offen offset:1024 sc1 lds
s_add_u32 m0, s70, 40960
s_add_u32 s56, s71, 10240
buffer_load_dwordx4 v2, s[44:47], s56 offen sc1 lds
buffer_load_dwordx4 v2, s[44:47], s56 offen offset:1024 sc1 lds
s_waitcnt lgkmcnt(0)
s_barrier
v_lshlrev_b32 v4, 3, v1
s_lshl_b32 s57, s13, 13
s_add_u32 s57, s57, 12582912
s_add_u32 s58, s57, 4096
buffer_load_dwordx2 v[40:41], v4, s[44:47], s57 offen offset:0 sc1
buffer_load_dwordx2 v[42:43], v4, s[44:47], s57 offen offset:512 sc1
buffer_load_dwordx2 v[44:45], v4, s[44:47], s57 offen offset:1024 sc1
buffer_load_dwordx2 v[46:47], v4, s[44:47], s57 offen offset:1536 sc1
buffer_load_dwordx2 v[48:49], v4, s[44:47], s57 offen offset:2048 sc1
buffer_load_dwordx2 v[50:51], v4, s[44:47], s57 offen offset:2560 sc1
buffer_load_dwordx2 v[52:53], v4, s[44:47], s57 offen offset:3072 sc1
buffer_load_dwordx2 v[54:55], v4, s[44:47], s57 offen offset:3584 sc1
buffer_load_dwordx2 v[56:57], v4, s[44:47], s58 offen offset:0 sc1
buffer_load_dwordx2 v[58:59], v4, s[44:47], s58 offen offset:512 sc1
buffer_load_dwordx2 v[60:61], v4, s[44:47], s58 offen offset:1024 sc1
buffer_load_dwordx2 v[62:63], v4, s[44:47], s58 offen offset:1536 sc1
buffer_load_dwordx2 v[64:65], v4, s[44:47], s58 offen offset:2048 sc1
buffer_load_dwordx2 v[66:67], v4, s[44:47], s58 offen offset:2560 sc1
buffer_load_dwordx2 v[68:69], v4, s[44:47], s58 offen offset:3072 sc1
buffer_load_dwordx2 v[70:71], v4, s[44:47], s58 offen offset:3584 sc1
s_waitcnt lgkmcnt(0)
s_barrier
s_add_u32 m0, s70, 0
s_add_u32 s56, s71, 12288
buffer_load_dwordx4 v2, s[44:47], s56 offen sc1 lds
buffer_load_dwordx4 v2, s[44:47], s56 offen offset:1024 sc1 lds
s_add_u32 m0, s70, 8192
s_add_u32 s56, s71, 14336
buffer_load_dwordx4 v2, s[44:47], s56 offen sc1 lds
buffer_load_dwordx4 v2, s[44:47], s56 offen offset:1024 sc1 lds
s_add_u32 m0, s73, 114688
s_add_u32 s56, s65, 802816
buffer_load_dwordx4 v13, s[52:55], s56 offen lds
s_add_u32 m0, s73, 116736
s_add_u32 s56, s65, 860160
buffer_load_dwordx4 v13, s[52:55], s56 offen lds
s_add_u32 m0, s73, 139264
s_add_u32 s56, s65, 917504
buffer_load_dwordx4 v13, s[52:55], s56 offen lds
s_add_u32 m0, s73, 141312
s_add_u32 s56, s65, 974848
buffer_load_dwordx4 v13, s[52:55], s56 offen lds
s_add_u32 m0, s73, 131072
s_add_u32 s56, s67, 917504
buffer_load_dwordx4 v10, s[52:55], s56 offen lds
s_add_u32 m0, s73, 133120
s_add_u32 s56, s67, 1032192
buffer_load_dwordx4 v10, s[52:55], s56 offen lds
s_waitcnt vmcnt(26)
s_waitcnt lgkmcnt(0)
s_barrier
s_add_u32 m0, s70, 16384
s_add_u32 s56, s71, 16384
buffer_load_dwordx4 v2, s[44:47], s56 offen sc1 lds
buffer_load_dwordx4 v2, s[44:47], s56 offen offset:1024 sc1 lds
s_add_u32 m0, s70, 24576
s_add_u32 s56, s71, 18432
buffer_load_dwordx4 v2, s[44:47], s56 offen sc1 lds
buffer_load_dwordx4 v2, s[44:47], s56 offen offset:1024 sc1 lds
s_add_u32 m0, s73, 122880
s_add_u32 s56, s66, 917504
buffer_load_dwordx4 v11, s[52:55], s56 offen lds
s_add_u32 m0, s73, 124928
s_add_u32 s56, s66, 1146880
buffer_load_dwordx4 v11, s[52:55], s56 offen lds
s_add_u32 m0, s73, 90112
s_add_u32 s56, s65, 1032192
buffer_load_dwordx4 v13, s[52:55], s56 offen lds
s_add_u32 m0, s73, 92160
s_add_u32 s56, s65, 1089536
buffer_load_dwordx4 v13, s[52:55], s56 offen lds
s_add_u32 m0, s73, 106496
s_add_u32 s56, s65, 1146880
buffer_load_dwordx4 v13, s[52:55], s56 offen lds
s_add_u32 m0, s73, 108544
s_add_u32 s56, s65, 1204224
buffer_load_dwordx4 v13, s[52:55], s56 offen lds
s_waitcnt vmcnt(20)
v_add_f32 v72, v40, v42
v_add_f32 v73, v44, v46
v_add_f32 v72, v72, v48
v_add_f32 v73, v73, v50
v_add_f32 v72, v72, v52
v_add_f32 v73, v73, v54
v_add_f32 v72, v72, v56
v_add_f32 v73, v73, v58
v_add_f32 v72, v72, v60
v_add_f32 v73, v73, v62
v_add_f32 v72, v72, v64
v_add_f32 v73, v73, v66
v_add_f32 v72, v72, v68
v_add_f32 v73, v73, v70
v_add_f32 v72, v72, v73
v_mov_b32 v77, v72
s_nop 1
v_permlane32_swap_b32 v72, v77
v_add_f32 v72, v72, v77
v_mul_f32 v72, 0xbd000000, v72
v_add_f32 v40, v40, v72
v_add_f32 v42, v42, v72
v_add_f32 v44, v44, v72
v_add_f32 v46, v46, v72
v_add_f32 v48, v48, v72
v_add_f32 v50, v50, v72
v_add_f32 v52, v52, v72
v_add_f32 v54, v54, v72
v_add_f32 v56, v56, v72
v_add_f32 v58, v58, v72
v_add_f32 v60, v60, v72
v_add_f32 v62, v62, v72
v_add_f32 v64, v64, v72
v_add_f32 v66, v66, v72
v_add_f32 v68, v68, v72
v_add_f32 v70, v70, v72
v_mul_f32 v73, v40, v40
v_mul_f32 v76, v42, v42
v_fmac_f32 v73, v44, v44
v_fmac_f32 v76, v46, v46
v_fmac_f32 v73, v48, v48
v_fmac_f32 v76, v50, v50
v_fmac_f32 v73, v52, v52
v_fmac_f32 v76, v54, v54
v_fmac_f32 v73, v56, v56
v_fmac_f32 v76, v58, v58
v_fmac_f32 v73, v60, v60
v_fmac_f32 v76, v62, v62
v_fmac_f32 v73, v64, v64
v_fmac_f32 v76, v66, v66
v_fmac_f32 v73, v68, v68
v_fmac_f32 v76, v70, v70
v_add_f32 v73, v73, v76
v_add_f32 v76, v41, v43
v_mul_f32 v73, 0x41800000, v73
v_add_f32 v73, v73, v45
v_add_f32 v76, v76, v47
v_add_f32 v73, v73, v49
v_add_f32 v76, v76, v51
v_add_f32 v73, v73, v53
v_add_f32 v76, v76, v55
v_add_f32 v73, v73, v57
v_add_f32 v76, v76, v59
v_add_f32 v73, v73, v61
v_add_f32 v76, v76, v63
v_add_f32 v73, v73, v65
v_add_f32 v76, v76, v67
v_add_f32 v73, v73, v69
v_add_f32 v76, v76, v71
v_add_f32 v76, v73, v76
v_mov_b32 v77, v76
s_nop 1
v_permlane32_swap_b32 v76, v77
v_add_f32 v76, v76, v77
v_mov_b32 v73, 0x3727c5ac
v_fmac_f32 v73, 0x3b000000, v76
v_rsq_f32 v76, v73
v_and_b32 v4, 31, v1
v_mul_f32 v74, 0xc0135761, v76
v_mul_f32 v77, v76, v76
v_mul_f32 v75, 0xbdd2d3e8, v76
v_mul_f32 v75, v75, v77
s_lshl_b32 s56, s4, 9
s_add_u32 s56, s56, 161792
v_lshl_add_u32 v4, v4, 4, s56
ds_write_b128 v4, v[72:75]
s_waitcnt vmcnt(14)
s_waitcnt lgkmcnt(0)
s_barrier
s_add_u32 m0, s70, 32768
s_add_u32 s56, s71, 20480
buffer_load_dwordx4 v2, s[44:47], s56 offen sc1 lds
buffer_load_dwordx4 v2, s[44:47], s56 offen offset:1024 sc1 lds
s_add_u32 m0, s70, 40960
s_add_u32 s56, s71, 22528
buffer_load_dwordx4 v2, s[44:47], s56 offen sc1 lds
buffer_load_dwordx4 v2, s[44:47], s56 offen offset:1024 sc1 lds
s_add_u32 m0, s73, 147456
s_add_u32 s56, s67, 1146880
buffer_load_dwordx4 v10, s[52:55], s56 offen lds
s_add_u32 m0, s73, 149504
s_add_u32 s56, s67, 1261568
buffer_load_dwordx4 v10, s[52:55], s56 offen lds
s_add_u32 m0, s73, 98304
s_add_u32 s56, s65, 1261568
buffer_load_dwordx4 v13, s[52:55], s56 offen lds
s_add_u32 m0, s73, 100352
s_add_u32 s56, s65, 1318912
buffer_load_dwordx4 v13, s[52:55], s56 offen lds
s_add_u32 m0, s73, 81920
s_add_u32 s56, s65, 1376256
buffer_load_dwordx4 v13, s[52:55], s56 offen lds
s_add_u32 m0, s73, 83968
s_add_u32 s56, s65, 1433600
buffer_load_dwordx4 v13, s[52:55], s56 offen lds
s_waitcnt vmcnt(12)
s_waitcnt lgkmcnt(0)
s_barrier
s_add_u32 m0, s70, 0
s_add_u32 s56, s71, 24576
buffer_load_dwordx4 v2, s[44:47], s56 offen sc1 lds
buffer_load_dwordx4 v2, s[44:47], s56 offen offset:1024 sc1 lds
s_add_u32 m0, s70, 8192
s_add_u32 s56, s71, 26624
buffer_load_dwordx4 v2, s[44:47], s56 offen sc1 lds
buffer_load_dwordx4 v2, s[44:47], s56 offen offset:1024 sc1 lds
s_add_u32 m0, s73, 114688
s_add_u32 s56, s67, 1376256
buffer_load_dwordx4 v10, s[52:55], s56 offen lds
s_add_u32 m0, s73, 116736
s_add_u32 s56, s67, 1490944
buffer_load_dwordx4 v10, s[52:55], s56 offen lds
s_add_u32 m0, s73, 73728
s_add_u32 s56, s66, 1376256
buffer_load_dwordx4 v11, s[52:55], s56 offen lds
s_add_u32 m0, s73, 75776
s_add_u32 s56, s66, 1605632
buffer_load_dwordx4 v11, s[52:55], s56 offen lds
s_add_u32 m0, s73, 65536
s_add_u32 s56, s65, 1490944
buffer_load_dwordx4 v13, s[52:55], s56 offen lds
s_add_u32 m0, s73, 67584
s_add_u32 s56, s65, 1548288
buffer_load_dwordx4 v13, s[52:55], s56 offen lds
s_waitcnt vmcnt(12)
s_waitcnt lgkmcnt(0)
s_barrier
s_add_u32 m0, s70, 16384
s_add_u32 s56, s71, 28672
buffer_load_dwordx4 v2, s[44:47], s56 offen sc1 lds
buffer_load_dwordx4 v2, s[44:47], s56 offen offset:1024 sc1 lds
s_add_u32 m0, s70, 24576
s_add_u32 s56, s71, 30720
buffer_load_dwordx4 v2, s[44:47], s56 offen sc1 lds
buffer_load_dwordx4 v2, s[44:47], s56 offen offset:1024 sc1 lds
s_add_u32 m0, s73, 90112
s_add_u32 s56, s65, 1605632
buffer_load_dwordx4 v13, s[52:55], s56 offen lds
s_add_u32 m0, s73, 92160
s_add_u32 s56, s65, 1662976
buffer_load_dwordx4 v13, s[52:55], s56 offen lds
s_add_u32 m0, s73, 139264
s_add_u32 s56, s67, 1605632
buffer_load_dwordx4 v10, s[52:55], s56 offen lds
s_add_u32 m0, s73, 141312
s_add_u32 s56, s67, 1720320
buffer_load_dwordx4 v10, s[52:55], s56 offen lds
s_add_u32 m0, s73, 131072
s_add_u32 s56, s65, 1720320
buffer_load_dwordx4 v13, s[52:55], s56 offen lds
s_add_u32 m0, s73, 133120
s_add_u32 s56, s65, 1777664
buffer_load_dwordx4 v13, s[52:55], s56 offen lds
s_lshl_b32 s56, s12, 9
s_add_u32 s56, s56, 14204928
v_and_b32 v4, 63, v1
v_lshlrev_b32 v4, 3, v4
s_mov_b32 s57, 0
L_poll_100008:
buffer_load_dwordx2 v[6:7], v4, s[44:47], s56 offen sc1
s_add_u32 s57, s57, 1
s_cmp_gt_u32 s57, 0x40000
s_cbranch_scc1 L_polld_100009
s_waitcnt vmcnt(0)
v_cmp_ne_u64 vcc, s[96:97], v[6:7]
s_cbranch_vccnz L_poll_100008
L_polld_100009:
s_waitcnt vmcnt(0)
s_mul_i32 s56, s12, 896
s_add_u32 s56, s56, 13631488
buffer_load_dword v80, v26, s[44:47], s56 offen sc1
s_add_u32 s56, s56, 14336
buffer_load_dword v81, v26, s[44:47], s56 offen sc1
s_add_u32 s56, s56, 14336
buffer_load_dword v82, v26, s[44:47], s56 offen sc1
s_add_u32 s56, s56, 14336
buffer_load_dword v83, v26, s[44:47], s56 offen sc1
s_add_u32 s56, s56, 14336
buffer_load_dword v84, v26, s[44:47], s56 offen sc1
s_add_u32 s56, s56, 14336
buffer_load_dword v85, v26, s[44:47], s56 offen sc1
s_add_u32 s56, s56, 14336
buffer_load_dword v86, v26, s[44:47], s56 offen sc1
s_add_u32 s56, s56, 14336
buffer_load_dword v87, v26, s[44:47], s56 offen sc1
s_add_u32 s56, s56, 14336
buffer_load_dword v88, v26, s[44:47], s56 offen sc1
s_add_u32 s56, s56, 14336
buffer_load_dword v89, v26, s[44:47], s56 offen sc1
s_add_u32 s56, s56, 14336
buffer_load_dword v90, v26, s[44:47], s56 offen sc1
s_add_u32 s56, s56, 14336
buffer_load_dword v91, v26, s[44:47], s56 offen sc1
s_add_u32 s56, s56, 14336
buffer_load_dword v92, v26, s[44:47], s56 offen sc1
s_add_u32 s56, s56, 14336
buffer_load_dword v93, v26, s[44:47], s56 offen sc1
s_add_u32 s56, s56, 14336
buffer_load_dword v94, v26, s[44:47], s56 offen sc1
s_add_u32 s56, s56, 14336
buffer_load_dword v95, v26, s[44:47], s56 offen sc1
s_add_u32 s56, s56, 14336
s_waitcnt lgkmcnt(0)
s_barrier
s_add_u32 m0, s63, 49152
s_add_u32 s56, s64, 0
buffer_load_dwordx4 v9, s[76:79], s56 offen lds
s_add_u32 m0, s63, 50176
s_add_u32 s56, s64, 8192
buffer_load_dwordx4 v9, s[76:79], s56 offen lds
s_add_u32 m0, s63, 57344
s_add_u32 s56, s64, 917504
buffer_load_dwordx4 v9, s[76:79], s56 offen lds
s_add_u32 m0, s63, 58368
s_add_u32 s56, s64, 925696
buffer_load_dwordx4 v9, s[76:79], s56 offen lds
s_add_u32 m0, s63, 98304
s_add_u32 s56, s64, 32768
buffer_load_dwordx4 v9, s[76:79], s56 offen lds
s_add_u32 m0, s63, 99328
s_add_u32 s56, s64, 40960
buffer_load_dwordx4 v9, s[76:79], s56 offen lds
s_waitcnt vmcnt(6)
v_add_f32 v80, v80, v88
v_add_f32 v81, v81, v89
v_add_f32 v82, v82, v90
v_add_f32 v83, v83, v91
v_add_f32 v84, v84, v92
v_add_f32 v85, v85, v93
v_add_f32 v86, v86, v94
v_add_f32 v87, v87, v95
v_add_f32 v80, v80, v84
v_add_f32 v81, v81, v85
v_add_f32 v82, v82, v86
v_add_f32 v83, v83, v87
v_add_f32 v80, v80, v81
v_add_f32 v82, v82, v83
v_add_f32 v80, v80, v82
v_add_u32 v4, 155648, v26
ds_write_b32 v4, v80
s_waitcnt lgkmcnt(0)
s_barrier
s_add_u32 m0, s63, 106496
s_add_u32 s56, s64, 950272
buffer_load_dwordx4 v9, s[76:79], s56 offen lds
s_add_u32 m0, s63, 107520
s_add_u32 s56, s64, 958464
buffer_load_dwordx4 v9, s[76:79], s56 offen lds
s_add_u32 m0, s63, 114688
s_add_u32 s56, s64, 65536
buffer_load_dwordx4 v9, s[76:79], s56 offen lds
s_add_u32 m0, s63, 115712
s_add_u32 s56, s64, 73728
buffer_load_dwordx4 v9, s[76:79], s56 offen lds
s_add_u32 m0, s63, 122880
s_add_u32 s56, s64, 983040
buffer_load_dwordx4 v9, s[76:79], s56 offen lds
s_add_u32 m0, s63, 123904
s_add_u32 s56, s64, 991232
buffer_load_dwordx4 v9, s[76:79], s56 offen lds
s_waitcnt lgkmcnt(0)
s_barrier
s_add_u32 m0, s63, 16384
s_add_u32 s56, s64, 98304
buffer_load_dwordx4 v9, s[76:79], s56 offen lds
s_add_u32 m0, s63, 17408
s_add_u32 s56, s64, 106496
buffer_load_dwordx4 v9, s[76:79], s56 offen lds
s_add_u32 m0, s63, 24576
s_add_u32 s56, s64, 1015808
buffer_load_dwordx4 v9, s[76:79], s56 offen lds
s_barrier
s_add_u32 m0, s63, 25600
s_add_u32 s56, s64, 1024000
buffer_load_dwordx4 v9, s[76:79], s56 offen lds
s_add_u32 m0, s63, 32768
s_add_u32 s56, s64, 131072
buffer_load_dwordx4 v9, s[76:79], s56 offen lds
s_add_u32 m0, s63, 33792
s_add_u32 s56, s64, 139264
buffer_load_dwordx4 v9, s[76:79], s56 offen lds
s_add_u32 m0, s63, 40960
s_add_u32 s56, s64, 1048576
buffer_load_dwordx4 v9, s[76:79], s56 offen lds
s_add_u32 m0, s63, 41984
s_add_u32 s56, s64, 1056768
buffer_load_dwordx4 v9, s[76:79], s56 offen lds
s_add_u32 m0, s63, 65536
s_add_u32 s56, s64, 163840
buffer_load_dwordx4 v9, s[76:79], s56 offen lds
s_add_u32 m0, s63, 66560
s_add_u32 s56, s64, 172032
buffer_load_dwordx4 v9, s[76:79], s56 offen lds
s_add_u32 m0, s63, 73728
s_add_u32 s56, s64, 1081344
buffer_load_dwordx4 v9, s[76:79], s56 offen lds
s_add_u32 m0, s63, 74752
s_add_u32 s56, s64, 1089536
buffer_load_dwordx4 v9, s[76:79], s56 offen lds
s_add_u32 m0, s63, 81920
s_add_u32 s56, s64, 196608
buffer_load_dwordx4 v9, s[76:79], s56 offen lds
s_add_u32 m0, s63, 82944
s_add_u32 s56, s64, 204800
buffer_load_dwordx4 v9, s[76:79], s56 offen lds
s_add_u32 m0, s63, 90112
s_add_u32 s56, s64, 1114112
buffer_load_dwordx4 v9, s[76:79], s56 offen lds
s_waitcnt lgkmcnt(0)
s_barrier
s_add_u32 m0, s63, 91136
s_add_u32 s56, s64, 1122304
buffer_load_dwordx4 v9, s[76:79], s56 offen lds
s_add_u32 m0, s63, 0
s_add_u32 s56, s64, 229376
buffer_load_dwordx4 v9, s[76:79], s56 offen lds
s_add_u32 m0, s63, 1024
s_add_u32 s56, s64, 237568
buffer_load_dwordx4 v9, s[76:79], s56 offen lds
s_add_u32 m0, s63, 8192
s_add_u32 s56, s64, 1146880
buffer_load_dwordx4 v9, s[76:79], s56 offen lds
s_add_u32 m0, s63, 9216
s_add_u32 s56, s64, 1155072
buffer_load_dwordx4 v9, s[76:79], s56 offen lds
s_add_u32 m0, s63, 131072
s_add_u32 s56, s64, 262144
buffer_load_dwordx4 v9, s[76:79], s56 offen lds
s_waitcnt vmcnt(17)
s_waitcnt lgkmcnt(0)
s_barrier
s_add_u32 m0, s63, 132096
s_add_u32 s56, s64, 270336
buffer_load_dwordx4 v9, s[76:79], s56 offen lds
s_add_u32 m0, s63, 139264
s_add_u32 s56, s64, 1179648
buffer_load_dwordx4 v9, s[76:79], s56 offen lds
s_add_u32 m0, s63, 140288
s_add_u32 s56, s64, 1187840
buffer_load_dwordx4 v9, s[76:79], s56 offen lds
s_waitcnt vmcnt(12)
s_waitcnt lgkmcnt(0)
s_barrier
s_add_u32 m0, s63, 49152
s_add_u32 s56, s64, 294912
buffer_load_dwordx4 v9, s[76:79], s56 offen lds
s_add_u32 m0, s63, 50176
s_add_u32 s56, s64, 303104
buffer_load_dwordx4 v9, s[76:79], s56 offen lds
s_add_u32 m0, s63, 57344
s_add_u32 s56, s64, 1212416
buffer_load_dwordx4 v9, s[76:79], s56 offen lds
s_add_u32 m0, s63, 58368
s_add_u32 s56, s64, 1220608
buffer_load_dwordx4 v9, s[76:79], s56 offen lds
s_add_u32 m0, s63, 98304
s_add_u32 s56, s64, 327680
buffer_load_dwordx4 v9, s[76:79], s56 offen lds
s_add_u32 m0, s63, 99328
s_add_u32 s56, s64, 335872
buffer_load_dwordx4 v9, s[76:79], s56 offen lds
s_add_u32 m0, s63, 106496
s_add_u32 s56, s64, 1245184
buffer_load_dwordx4 v9, s[76:79], s56 offen lds
s_add_u32 m0, s63, 107520
s_add_u32 s56, s64, 1253376
buffer_load_dwordx4 v9, s[76:79], s56 offen lds
s_waitcnt vmcnt(12)
s_waitcnt lgkmcnt(0)
s_barrier
s_add_u32 m0, s63, 16384
s_add_u32 s56, s64, 360448
buffer_load_dwordx4 v9, s[76:79], s56 offen lds
s_add_u32 m0, s63, 17408
s_add_u32 s56, s64, 368640
buffer_load_dwordx4 v9, s[76:79], s56 offen lds
s_add_u32 m0, s63, 24576
s_add_u32 s56, s64, 1277952
buffer_load_dwordx4 v9, s[76:79], s56 offen lds
s_add_u32 m0, s63, 25600
s_add_u32 s56, s64, 1286144
buffer_load_dwordx4 v9, s[76:79], s56 offen lds
s_add_u32 m0, s63, 114688
s_add_u32 s56, s64, 393216
buffer_load_dwordx4 v9, s[76:79], s56 offen lds
s_add_u32 m0, s63, 115712
s_add_u32 s56, s64, 401408
buffer_load_dwordx4 v9, s[76:79], s56 offen lds
s_add_u32 m0, s63, 122880
s_add_u32 s56, s64, 1310720
buffer_load_dwordx4 v9, s[76:79], s56 offen lds
s_add_u32 m0, s63, 123904
s_add_u32 s56, s64, 1318912
buffer_load_dwordx4 v9, s[76:79], s56 offen lds
s_waitcnt vmcnt(12)
s_waitcnt lgkmcnt(0)
s_barrier
s_add_u32 m0, s63, 32768
s_add_u32 s56, s64, 425984
buffer_load_dwordx4 v9, s[76:79], s56 offen lds
s_add_u32 m0, s63, 33792
s_add_u32 s56, s64, 434176
buffer_load_dwordx4 v9, s[76:79], s56 offen lds
s_add_u32 m0, s63, 40960
s_add_u32 s56, s64, 1343488
buffer_load_dwordx4 v9, s[76:79], s56 offen lds
s_add_u32 m0, s63, 41984
s_add_u32 s56, s64, 1351680
buffer_load_dwordx4 v9, s[76:79], s56 offen lds
s_waitcnt vmcnt(8)
s_waitcnt lgkmcnt(0)
s_barrier
s_waitcnt vmcnt(0)
s_waitcnt lgkmcnt(0)
s_barrier
s_waitcnt lgkmcnt(0)
s_barrier
s_barrier
s_barrier
s_or_b32 s56, s2, s3
s_cmp_lg_u32 s56, 0
s_cbranch_scc1 L_end
v_mov_b32 v28, 0
v_mov_b32 v29, 0
s_mov_b64 exec, 1
buffer_store_dwordx2 v[28:29], v33, s[84:87], 0 offen sc1
L_end:
s_endpgm
.section .rodata,"a"
.p2align 6
.amdhsa_kernel sequential_preLN__sliding_local_dilated__geglu_ffn__prompt_kernel
  .amdhsa_next_free_vgpr 168
  .amdhsa_next_free_sgpr 102
  .amdhsa_accum_offset 168
  .amdhsa_group_segment_fixed_size 0
  .amdhsa_kernarg_size 80
  .amdhsa_user_sgpr_count 2
  .amdhsa_user_sgpr_kernarg_segment_ptr 1
  .amdhsa_system_sgpr_workgroup_id_x 1
.end_amdhsa_kernel
```
